```python
import torch

def _softmax(x, axis=-1):
    return torch.softmax(x, dim=axis)
def _gelu(x):
    return torch.nn.functional.gelu(x, approximate="tanh")
def _silu(x):
    return torch.nn.functional.silu(x)
def _sigmoid(x):
    return torch.sigmoid(x)
def _layernorm(x, axis=-1, eps=1e-5):
    m = x.mean(dim=axis, keepdim=True)
    v = x.var(dim=axis, keepdim=True, unbiased=False)
    return (x - m) / torch.sqrt(v + eps)
def _scatter_add(tgt, idx, src, axis=0):
    return tgt.clone().index_add_(axis, idx, src)
def _segment_sum(src, seg, n):
    out = torch.zeros((n,) + src.shape[1:], dtype=src.dtype)
    return out.index_add_(0, seg, src)
def _pad(x, pw):
    flat = tuple(v for pair in reversed(pw) for v in pair)
    return torch.nn.functional.pad(x, flat)

kernel_name = 'gated_mix__ssm_conv_h3__ssm_conv_s4d__prompt'

def setup_inputs():

    _w = (lambda a: (lambda t: t.to(torch.bfloat16) if t.is_floating_point() else t)(torch.as_tensor(a)))
    def _A_setup():
        B, S, D = 1, 2048, 640
        ks = 4
        return {
            "q": _w((lambda *s: torch.randn(*s, dtype=torch.bfloat16) * 0.05)(B, S, D)),
            "k": _w((lambda *s: torch.randn(*s, dtype=torch.bfloat16) * 0.4)(B, S, D)),
            "v": _w((lambda *s: torch.randn(*s, dtype=torch.bfloat16) * 0.2)(B, S, D)),
            "shift_k": _w((lambda *s: torch.randn(*s, dtype=torch.bfloat16) * 0.4)(D, ks) * 0.5),
            "ssm_k": _w((lambda *s: torch.randn(*s, dtype=torch.bfloat16) * 0.4)(D, S) * (1.0 / S ** 0.5)),
            "ssm_D": _w((lambda *s: torch.randn(*s, dtype=torch.bfloat16) * 0.2)(D)),
        }
    _A_in = _A_setup()

    def _B_setup():
        Bsz, L, D, N = 1, 2048, 640, 192
        return {
            "u": _w((lambda *s: torch.randn(*s, dtype=torch.bfloat16) * 0.05)(Bsz, L, D)),
            "log_A_real": _w((lambda *s: torch.randn(*s, dtype=torch.bfloat16) * 3.2)(D, N) * 0.5),
            "A_imag": _w((lambda *s: torch.randn(*s, dtype=torch.bfloat16) * 0.05)(D, N) * 3.14),
            "C_real": _w((lambda *s: torch.randn(*s, dtype=torch.bfloat16) * 0.1)(D, N) / N ** 0.5),
            "C_imag": _w((lambda *s: torch.randn(*s, dtype=torch.bfloat16) * 0.1)(D, N) / N ** 0.5),
            "log_dt": _w((lambda *s: torch.randn(*s, dtype=torch.bfloat16) * 0.05)(D) * 0.5 - 4.0),
            "D_skip": _w((lambda *s: torch.randn(*s, dtype=torch.bfloat16) * 0.05)(D)),
        }
    _B_in = _B_setup()

    return {
        "A_q": _A_in["q"],
        "A_k": _A_in["k"],
        "A_v": _A_in["v"],
        "A_shift_k": _A_in["shift_k"],
        "A_ssm_k": _A_in["ssm_k"],
        "A_ssm_D": _A_in["ssm_D"],
        "B_u": _B_in["u"],
        "B_log_A_real": _B_in["log_A_real"],
        "B_A_imag": _B_in["A_imag"],
        "B_C_real": _B_in["C_real"],
        "B_C_imag": _B_in["C_imag"],
        "B_log_dt": _B_in["log_dt"],
        "B_D_skip": _B_in["D_skip"],
        "gate_w": _w((lambda *s: torch.randn(*s, dtype=torch.bfloat16) * 0.05)(640) * 16.0),
    }

def reference(A_q, A_k, A_v, A_shift_k, A_ssm_k, A_ssm_D, B_u, B_log_A_real, B_A_imag, B_C_real, B_C_imag, B_log_dt, B_D_skip, gate_w):
    def _A_ref(q, k, v, shift_k, ssm_k, ssm_D):
        B, S, D = q.shape
        ks = shift_k.shape[-1]
        k_pad = _pad(k, ((0, 0), (ks - 1, 0), (0, 0)))
        k_shift = torch.zeros_like(k)
        for t in range(ks):
            k_shift = k_shift + k_pad[:, t:t + S, :] * shift_k[:, ks - 1 - t][None, None, :]
        kv = k_shift * v
        L = 2 * S
        kv_pad = _pad(kv, ((0, 0), (0, S), (0, 0)))
        kf_pad = _pad(ssm_k, ((0, 0), (0, S)))
        kv_f = (lambda x, axes=(-2,-1): torch.fft.rfft2(x.float(), dim=axes))(kv_pad[:, None, :, :], axes=(1, 2))
        kf_f = (lambda x, axes=(-2,-1): torch.fft.rfft2(x.float(), dim=axes))(kf_pad[:, None, :], axes=(1, 2))
        kf_f = (lambda x, *d: x.permute(*d))(kf_f, 1, 2, 0)
        y_f = kv_f * kf_f[None, :, :, :]
        y = (lambda x, s, axes=(-2,-1): torch.fft.irfft2(x, s=s, dim=axes).to(torch.bfloat16))(y_f, (1, L), axes=(1, 2))[:, 0, :S, :]
        y = y + kv * ssm_D[None, None, :]
        return q * y

    def _B_ref(u, log_A_real, A_imag, C_real, C_imag, log_dt, D_skip):
        L = u.shape[1]
        dt = torch.exp(log_dt)
        A = -torch.exp(log_A_real) + 1j * A_imag
        C = (C_real + 1j * C_imag) * dt[:, None]
        pos = (lambda x, dt: x.to(dt))(torch.arange(L), log_dt.dtype)
        P = torch.exp((A * dt[:, None])[:, :, None] * pos[None, None, :])
        K = 2.0 * torch.einsum("dn,dnl->dl", C, P).real
        L2 = 2 * L
        u_t = (lambda x, *d: x.permute(*d))(u, 0, 2, 1)
        Kf = (lambda x, *a, **k: torch.fft.rfft(x.float(), *a, **k))(K, L2)
        Uf = (lambda x, *a, **k: torch.fft.rfft(x.float(), *a, **k))(u_t, L2)
        y = (lambda x, *a, **k: torch.fft.irfft(x, *a, **k).to(torch.bfloat16))(Uf * Kf[None, :, :], L2)[:, :, :L]
        y = (lambda x, *d: x.permute(*d))(y, 0, 2, 1)
        return y + u * D_skip[None, None, :]

    x = A_q
    g = _sigmoid((x * gate_w).sum(-1, keepdims=True))
    a = _A_ref(x, A_k, A_v, A_shift_k, A_ssm_k, A_ssm_D)
    b = _B_ref(x, B_log_A_real, B_A_imag, B_C_real, B_C_imag, B_log_dt, B_D_skip)
    return g * a + (1 - g) * b
```

```asm
; @launch kernel=k1_kernel grid=(256,1,1) block=(1024,1,1) lds=101952
; @launch kernel=k2_kernel grid=(256,1,1) block=(768,1,1) lds=156032
.amdgcn_target "amdgcn-amd-amdhsa--gfx950"
.text
.globl k1_kernel
.p2align 8
.type k1_kernel,@function
k1_kernel:
    s_cmp_ge_u32 s2, 256
    s_cbranch_scc1 L_k1_end
    v_cmp_gt_u32 vcc, 64, v0
    s_cbranch_vccz L_cpf_3_skip
    s_getpc_b64 s[20:21]
L_cpf_3_pc:
    s_sub_u32 s20, s20, L_cpf_3_pc-k1_kernel
    s_subb_u32 s21, s21, 0
    v_lshlrev_b32 v2, 7, v0
    s_add_u32 s22, s20, k1_kernel-k1_kernel+0
    s_addc_u32 s23, s21, 0
    v_mov_b32 v5, s23
    v_add_co_u32 v4, vcc, s22, v2
    v_addc_co_u32 v5, vcc, 0, v5, vcc
    v_cmp_gt_u32 vcc, 58, v0
    s_and_saveexec_b64 s[24:25], vcc
    global_load_dword v103, v[4:5], off
    s_mov_b64 exec, s[24:25]
    s_add_u32 s22, s20, k2_kernel-k1_kernel+0
    s_addc_u32 s23, s21, 0
    v_mov_b32 v5, s23
    v_add_co_u32 v4, vcc, s22, v2
    v_addc_co_u32 v5, vcc, 0, v5, vcc
    global_load_dword v103, v[4:5], off
    s_add_u32 s22, s20, k2_kernel-k1_kernel+8192
    s_addc_u32 s23, s21, 0
    v_mov_b32 v5, s23
    v_add_co_u32 v4, vcc, s22, v2
    v_addc_co_u32 v5, vcc, 0, v5, vcc
    v_cmp_gt_u32 vcc, 12, v0
    s_and_saveexec_b64 s[24:25], vcc
    global_load_dword v103, v[4:5], off
    s_mov_b64 exec, s[24:25]
L_cpf_3_skip:
    v_lshrrev_b32 v1, 6, v0
    v_and_b32 v100, 63, v0
    s_load_dwordx2 s[44:45], s[0:1], 128
    v_readfirstlane_b32 s51, v1
    v_mov_b32 v2, 0
    v_lshlrev_b32 v3, 2, v100
    s_cmp_eq_u32 s51, 15
    s_cbranch_scc0 L_k1_noinit
    v_cmp_gt_u32 vcc, 16, v100
    s_and_saveexec_b64 s[52:53], vcc
    ds_write_b32 v3, v2
    s_mov_b64 exec, s[52:53]
    s_waitcnt lgkmcnt(0)
L_k1_noinit:
    s_cmp_lt_u32 s51, 6
    s_cbranch_scc1 L_k1_G01
    s_cmp_ge_u32 s51, 14
    s_cbranch_scc1 L_k1_misc
    s_cmp_ge_u32 s51, 10
    s_cbranch_scc1 L_k1_T1
    s_cmp_lt_u32 s2, 128
    s_cbranch_scc0 L_k1_notA
    s_cmp_eq_u32 s51, 9
    s_cbranch_scc1 L_k1_idle
    s_sub_u32 s55, s51, 6
    s_mul_i32 s50, s2, 3
    s_add_u32 s50, s50, 2
    s_mov_b32 s56, 2
    s_branch L_k1_G
L_k1_notA:
    s_cmp_lt_u32 s2, 192
    s_cbranch_scc0 L_k1_idle
    s_add_u32 s50, s2, 128
    s_sub_u32 s55, s51, 6
    s_mov_b32 s56, 1
    s_branch L_k1_T
L_k1_T1:
    s_mov_b32 s50, s2
    s_sub_u32 s55, s51, 10
    s_mov_b32 s56, 0
    s_branch L_k1_T
L_k1_G01:
    s_mov_b32 s55, s51
    s_cmp_ge_u32 s55, 3
    s_cselect_b32 s56, 1, 0
    s_mul_i32 s57, s56, 3
    s_sub_u32 s55, s55, s57
    s_mul_i32 s50, s2, 3
    s_lshl_b32 s57, s2, 1
    s_add_u32 s57, s57, 128
    s_cmp_lt_u32 s2, 128
    s_cselect_b32 s50, s50, s57
    s_add_u32 s50, s50, s56
    s_branch L_k1_G
L_k1_idle:
    s_barrier
    s_endpgm
L_k1_T:
    s_setprio 3
    s_load_dwordx4 s[4:7], s[0:1], 0
    s_load_dwordx4 s[8:11], s[0:1], 16
    s_and_b32 s36, s50, 7
    s_lshr_b32 s37, s50, 3
    s_mul_hi_u32 s38, s37, 429496730
    s_mul_i32 s39, s38, 10
    s_sub_u32 s37, s37, s39
    s_lshl_b32 s38, s38, 3
    s_add_u32 s36, s36, s38
    s_mul_i32 s40, s56, 25600
    s_add_u32 s40, s40, 50752
    v_lshrrev_b32 v2, 3, v100
    v_mul_u32_u24 v2, 1280, v2
    v_and_b32 v3, 7, v100
    s_mul_i32 s41, s36, 81920
    s_lshl_b32 s42, s37, 7
    s_add_u32 s41, s41, s42
    v_add_u32 v2, s41, v2
    s_waitcnt lgkmcnt(0)
    s_mov_b32 s16, s4
    s_mov_b32 s17, s5
    s_mov_b32 s18, 2621440
    s_mov_b32 s19, 0x00020000
    s_mov_b32 s20, s6
    s_mov_b32 s21, s7
    s_mov_b32 s22, 2621440
    s_mov_b32 s23, 0x00020000
    s_mov_b32 s24, s8
    s_mov_b32 s25, s9
    s_mov_b32 s26, 2621440
    s_mov_b32 s27, 0x00020000
    s_mov_b32 s28, s10
    s_mov_b32 s29, s11
    s_mov_b32 s30, 5120
    s_mov_b32 s31, 0x00020000
    s_mov_b32 s32, s44
    s_mov_b32 s33, s45
    s_mov_b32 s34, 10821632
    s_mov_b32 s35, 0x00020000
    s_barrier
    s_add_u32 s57, s55, 0
    s_and_b32 s58, s57, 7
    v_xor_b32 v4, s58, v3
    v_lshlrev_b32 v4, 4, v4
    v_add_u32 v4, v2, v4
    s_mul_i32 s59, s57, 10240
    v_add_u32 v4, s59, v4
    v_subrev_u32 v4, 3840, v4
    s_lshl_b32 s59, s57, 10
    s_add_u32 s59, s59, s40
    s_add_u32 s59, s59, 0
    s_mov_b32 m0, s59
    s_nop 0
    buffer_load_dwordx4 v4, s[20:23], 0 offen  lds
    s_add_u32 s57, s55, 4
    s_and_b32 s58, s57, 7
    v_xor_b32 v4, s58, v3
    v_lshlrev_b32 v4, 4, v4
    v_add_u32 v4, v2, v4
    s_mul_i32 s59, s57, 10240
    v_add_u32 v4, s59, v4
    v_subrev_u32 v4, 3840, v4
    s_lshl_b32 s59, s57, 10
    s_add_u32 s59, s59, s40
    s_add_u32 s59, s59, 0
    s_mov_b32 m0, s59
    s_nop 0
    buffer_load_dwordx4 v4, s[20:23], 0 offen  lds
    s_cmp_eq_u32 s55, 0
    s_cbranch_scc0 L_k1_nok8
    s_mov_b32 s57, 8
    s_and_b32 s58, s57, 7
    v_xor_b32 v4, s58, v3
    v_lshlrev_b32 v4, 4, v4
    v_add_u32 v4, v2, v4
    s_mul_i32 s59, s57, 10240
    v_add_u32 v4, s59, v4
    v_subrev_u32 v4, 3840, v4
    s_lshl_b32 s59, s57, 10
    s_add_u32 s59, s59, s40
    s_add_u32 s59, s59, 0
    s_mov_b32 m0, s59
    s_nop 0
    buffer_load_dwordx4 v4, s[20:23], 0 offen  lds
L_k1_nok8:
    s_add_u32 s57, s55, 0
    s_and_b32 s58, s57, 7
    v_xor_b32 v4, s58, v3
    v_lshlrev_b32 v4, 4, v4
    v_add_u32 v4, v2, v4
    s_mul_i32 s59, s57, 10240
    v_add_u32 v4, s59, v4
    s_lshl_b32 s59, s57, 10
    s_add_u32 s59, s59, s40
    s_add_u32 s59, s59, 9216
    s_mov_b32 m0, s59
    s_nop 0
    buffer_load_dwordx4 v4, s[24:27], 0 offen  lds
    s_add_u32 s57, s55, 4
    s_and_b32 s58, s57, 7
    v_xor_b32 v4, s58, v3
    v_lshlrev_b32 v4, 4, v4
    v_add_u32 v4, v2, v4
    s_mul_i32 s59, s57, 10240
    v_add_u32 v4, s59, v4
    s_lshl_b32 s59, s57, 10
    s_add_u32 s59, s59, s40
    s_add_u32 s59, s59, 9216
    s_mov_b32 m0, s59
    s_nop 0
    buffer_load_dwordx4 v4, s[24:27], 0 offen  lds
    s_add_u32 s57, s55, 0
    s_and_b32 s58, s57, 7
    v_xor_b32 v4, s58, v3
    v_lshlrev_b32 v4, 4, v4
    v_add_u32 v4, v2, v4
    s_mul_i32 s59, s57, 10240
    v_add_u32 v4, s59, v4
    s_lshl_b32 s59, s57, 10
    s_add_u32 s59, s59, s40
    s_add_u32 s59, s59, 17408
    s_mov_b32 m0, s59
    s_nop 0
    buffer_load_dwordx4 v4, s[16:19], 0 offen  lds
    s_add_u32 s57, s55, 4
    s_and_b32 s58, s57, 7
    v_xor_b32 v4, s58, v3
    v_lshlrev_b32 v4, 4, v4
    v_add_u32 v4, v2, v4
    s_mul_i32 s59, s57, 10240
    v_add_u32 v4, s59, v4
    s_lshl_b32 s59, s57, 10
    s_add_u32 s59, s59, s40
    s_add_u32 s59, s59, 17408
    s_mov_b32 m0, s59
    s_nop 0
    buffer_load_dwordx4 v4, s[16:19], 0 offen  lds
    v_lshrrev_b32 v5, 3, v100
    s_lshl_b32 s58, s55, 3
    v_add_u32 v6, s58, v5
    v_lshlrev_b32 v7, 4, v6
    s_lshl_b32 s59, s37, 9
    v_add_u32 v7, s59, v7
    buffer_load_dwordx4 v[36:39], v7, s[28:31], 0 offen
    v_lshrrev_b32 v8, 2, v6
    v_and_b32 v9, 3, v6
    v_xor_b32 v10, v8, v3
    v_add_u32 v11, 1, v3
    v_and_b32 v11, 7, v11
    v_xor_b32 v11, v8, v11
    v_lshlrev_b32 v12, 10, v3
    v_lshl_add_u32 v12, v9, 2, v12
    v_add_u32 v12, s40, v12
    v_lshl_add_u32 v13, v10, 4, v12
    v_lshl_add_u32 v14, v11, 4, v12
    v_lshlrev_b32 v15, 1, v6
    s_lshl_b32 s58, s37, 6
    v_add_u32 v15, s58, v15
    v_mul_u32_u24 v15, 4224, v15
    v_lshlrev_b32 v16, 4, v3
    v_sub_u32 v15, v15, v16
    s_lshl_b32 s58, s36, 7
    s_sub_u32 s58, 4080, s58
    v_add_u32 v15, s58, v15
    s_mov_b32 s41, 2703360
    s_movk_i32 s42, 4224
    s_mov_b32 s43, 2707584
    s_mov_b32 s46, 0xffff0000
    s_mov_b32 s47, 0x05040100
    s_mov_b32 s48, 0x07060302
    s_lshl_b32 s57, s56, 2
    s_waitcnt vmcnt(0)
    v_mov_b32 v17, s57
    v_mov_b32 v18, 1
    s_mov_b64 exec, 1
    ds_add_u32 v17, v18
    s_mov_b64 exec, -1
    s_mov_b32 s64, 0x40000
L_gs_3:
    ds_read_b32 v18, v17
    s_waitcnt lgkmcnt(0)
    v_readfirstlane_b32 s63, v18
    s_sub_u32 s64, s64, 1
    s_cbranch_scc1 L_gs_3_done
    s_cmp_ge_u32 s63, 4
    s_cbranch_scc1 L_gs_3_done
    s_sleep 1
    s_branch L_gs_3
L_gs_3_done:
    ds_read_b32 v48, v13 offset:0
    ds_read_b32 v49, v13 offset:128
    ds_read_b32 v50, v13 offset:256
    ds_read_b32 v51, v13 offset:384
    ds_read_b32 v52, v13 offset:512
    ds_read_b32 v53, v13 offset:640
    ds_read_b32 v54, v13 offset:768
    ds_read_b32 v55, v13 offset:896
    ds_read_b32 v56, v14 offset:1024
    ds_read_b32 v57, v14 offset:1152
    ds_read_b32 v58, v14 offset:1280
    ds_read_b32 v20, v13 offset:9216
    ds_read_b32 v21, v13 offset:9344
    ds_read_b32 v22, v13 offset:9472
    ds_read_b32 v23, v13 offset:9600
    ds_read_b32 v24, v13 offset:9728
    ds_read_b32 v25, v13 offset:9856
    ds_read_b32 v26, v13 offset:9984
    ds_read_b32 v27, v13 offset:10112
    v_lshlrev_b32 v40, 16, v36
    v_and_b32 v41, s46, v36
    v_lshlrev_b32 v42, 16, v37
    v_and_b32 v43, s46, v37
    v_lshlrev_b32 v44, 16, v38
    v_and_b32 v45, s46, v38
    v_lshlrev_b32 v46, 16, v39
    v_and_b32 v47, s46, v39
    s_waitcnt lgkmcnt(8)
    v_lshlrev_b32 v72, 16, v48
    v_lshlrev_b32 v73, 16, v49
    v_lshlrev_b32 v74, 16, v50
    v_lshlrev_b32 v75, 16, v51
    v_lshlrev_b32 v76, 16, v52
    v_lshlrev_b32 v77, 16, v53
    v_lshlrev_b32 v78, 16, v54
    v_lshlrev_b32 v79, 16, v55
    v_lshlrev_b32 v80, 16, v56
    v_lshlrev_b32 v81, 16, v57
    v_lshlrev_b32 v82, 16, v58
    ds_read_b32 v28, v13 offset:17408
    ds_read_b32 v29, v13 offset:17536
    ds_read_b32 v30, v13 offset:17664
    ds_read_b32 v31, v13 offset:17792
    ds_read_b32 v32, v13 offset:17920
    ds_read_b32 v33, v13 offset:18048
    ds_read_b32 v34, v13 offset:18176
    ds_read_b32 v35, v13 offset:18304
    v_mul_f32 v60, v40, v75
    v_mul_f32 v61, v40, v76
    v_mul_f32 v62, v40, v77
    v_mul_f32 v63, v40, v78
    v_mul_f32 v64, v40, v79
    v_mul_f32 v65, v40, v80
    v_mul_f32 v66, v40, v81
    v_mul_f32 v67, v40, v82
    v_fmac_f32 v60, v41, v74
    v_fmac_f32 v61, v41, v75
    v_fmac_f32 v62, v41, v76
    v_fmac_f32 v63, v41, v77
    v_fmac_f32 v64, v41, v78
    v_fmac_f32 v65, v41, v79
    v_fmac_f32 v66, v41, v80
    v_fmac_f32 v67, v41, v81
    v_fmac_f32 v60, v42, v73
    v_fmac_f32 v61, v42, v74
    v_fmac_f32 v62, v42, v75
    v_fmac_f32 v63, v42, v76
    v_fmac_f32 v64, v42, v77
    v_fmac_f32 v65, v42, v78
    v_fmac_f32 v66, v42, v79
    v_fmac_f32 v67, v42, v80
    v_fmac_f32 v60, v43, v72
    v_fmac_f32 v61, v43, v73
    v_fmac_f32 v62, v43, v74
    v_fmac_f32 v63, v43, v75
    v_fmac_f32 v64, v43, v76
    v_fmac_f32 v65, v43, v77
    v_fmac_f32 v66, v43, v78
    v_fmac_f32 v67, v43, v79
    s_waitcnt lgkmcnt(8)
    v_lshlrev_b32 v72, 16, v20
    v_lshlrev_b32 v73, 16, v21
    v_lshlrev_b32 v74, 16, v22
    v_lshlrev_b32 v75, 16, v23
    v_lshlrev_b32 v76, 16, v24
    v_lshlrev_b32 v77, 16, v25
    v_lshlrev_b32 v78, 16, v26
    v_lshlrev_b32 v79, 16, v27
    v_mul_f32 v60, v60, v72
    v_mul_f32 v61, v61, v73
    v_mul_f32 v62, v62, v74
    v_mul_f32 v63, v63, v75
    v_mul_f32 v64, v64, v76
    v_mul_f32 v65, v65, v77
    v_mul_f32 v66, v66, v78
    v_mul_f32 v67, v67, v79
    v_cvt_pk_bf16_f32 v84, v67, v66
    v_cvt_pk_bf16_f32 v85, v65, v64
    v_cvt_pk_bf16_f32 v86, v63, v62
    v_cvt_pk_bf16_f32 v87, v61, v60
    buffer_store_dwordx4 v[84:87], v15, s[32:35], s41 offen sc1
    v_and_b32 v72, s46, v48
    v_and_b32 v73, s46, v49
    v_and_b32 v74, s46, v50
    v_and_b32 v75, s46, v51
    v_and_b32 v76, s46, v52
    v_and_b32 v77, s46, v53
    v_and_b32 v78, s46, v54
    v_and_b32 v79, s46, v55
    v_and_b32 v80, s46, v56
    v_and_b32 v81, s46, v57
    v_and_b32 v82, s46, v58
    v_mul_f32 v60, v44, v75
    v_mul_f32 v61, v44, v76
    v_mul_f32 v62, v44, v77
    v_mul_f32 v63, v44, v78
    v_mul_f32 v64, v44, v79
    v_mul_f32 v65, v44, v80
    v_mul_f32 v66, v44, v81
    v_mul_f32 v67, v44, v82
    v_fmac_f32 v60, v45, v74
    v_fmac_f32 v61, v45, v75
    v_fmac_f32 v62, v45, v76
    v_fmac_f32 v63, v45, v77
    v_fmac_f32 v64, v45, v78
    v_fmac_f32 v65, v45, v79
    v_fmac_f32 v66, v45, v80
    v_fmac_f32 v67, v45, v81
    v_fmac_f32 v60, v46, v73
    v_fmac_f32 v61, v46, v74
    v_fmac_f32 v62, v46, v75
    v_fmac_f32 v63, v46, v76
    v_fmac_f32 v64, v46, v77
    v_fmac_f32 v65, v46, v78
    v_fmac_f32 v66, v46, v79
    v_fmac_f32 v67, v46, v80
    v_fmac_f32 v60, v47, v72
    v_fmac_f32 v61, v47, v73
    v_fmac_f32 v62, v47, v74
    v_fmac_f32 v63, v47, v75
    v_fmac_f32 v64, v47, v76
    v_fmac_f32 v65, v47, v77
    v_fmac_f32 v66, v47, v78
    v_fmac_f32 v67, v47, v79
    v_and_b32 v72, s46, v20
    v_and_b32 v73, s46, v21
    v_and_b32 v74, s46, v22
    v_and_b32 v75, s46, v23
    v_and_b32 v76, s46, v24
    v_and_b32 v77, s46, v25
    v_and_b32 v78, s46, v26
    v_and_b32 v79, s46, v27
    v_mul_f32 v60, v60, v72
    v_mul_f32 v61, v61, v73
    v_mul_f32 v62, v62, v74
    v_mul_f32 v63, v63, v75
    v_mul_f32 v64, v64, v76
    v_mul_f32 v65, v65, v77
    v_mul_f32 v66, v66, v78
    v_mul_f32 v67, v67, v79
    v_cvt_pk_bf16_f32 v88, v67, v66
    v_cvt_pk_bf16_f32 v89, v65, v64
    v_cvt_pk_bf16_f32 v90, v63, v62
    v_cvt_pk_bf16_f32 v91, v61, v60
    buffer_store_dwordx4 v[88:91], v15, s[32:35], s43 offen sc1
    s_waitcnt lgkmcnt(0)
    v_perm_b32 v92, v34, v35, s47
    v_perm_b32 v93, v32, v33, s47
    v_perm_b32 v94, v30, v31, s47
    v_perm_b32 v95, v28, v29, s47
    buffer_store_dwordx4 v[92:95], v15, s[32:35], 0 offen sc1
    v_perm_b32 v96, v34, v35, s48
    v_perm_b32 v97, v32, v33, s48
    v_perm_b32 v98, v30, v31, s48
    v_perm_b32 v99, v28, v29, s48
    buffer_store_dwordx4 v[96:99], v15, s[32:35], s42 offen sc1
    s_endpgm
L_k1_G:
    s_load_dwordx8 s[4:11], s[0:1], 56
    s_load_dwordx4 s[12:15], s[0:1], 88
    s_mov_b32 s60, 0x3fb8aa3b
    s_mov_b32 s61, 0x32a57060
    s_mov_b32 s62, 0x3f317218
    s_mul_i32 s52, s50, 384
    s_lshl_b32 s53, s55, 7
    s_add_u32 s52, s52, s53
    v_lshl_add_u32 v1, v100, 1, s52
    s_lshl_b32 s53, s50, 1
    v_mov_b32 v7, s53
    s_mul_i32 s49, s56, 13824
    s_add_u32 s49, s49, 64
    s_mul_i32 s54, s55, 4608
    s_add_u32 s54, s54, s49
    s_mov_b32 m0, s54
    v_and_b32 v8, 15, v100
    v_lshrrev_b32 v9, 4, v100
    v_mul_u32_u24 v50, 288, v8
    v_lshl_add_u32 v50, v9, 4, v50
    v_add_u32 v50, s54, v50
    s_waitcnt lgkmcnt(0)
    s_mov_b32 s16, s4
    s_mov_b32 s17, s5
    s_mov_b32 s18, 245760
    s_mov_b32 s19, 0x00020000
    s_mov_b32 s20, s6
    s_mov_b32 s21, s7
    s_mov_b32 s22, 245760
    s_mov_b32 s23, 0x00020000
    s_mov_b32 s24, s8
    s_mov_b32 s25, s9
    s_mov_b32 s26, 245760
    s_mov_b32 s27, 0x00020000
    s_mov_b32 s28, s10
    s_mov_b32 s29, s11
    s_mov_b32 s30, 245760
    s_mov_b32 s31, 0x00020000
    s_mov_b32 s32, s12
    s_mov_b32 s33, s13
    s_mov_b32 s34, 1280
    s_mov_b32 s35, 0x00020000
    s_mov_b32 s36, s14
    s_mov_b32 s37, s15
    s_mov_b32 s38, 1280
    s_mov_b32 s39, 0x00020000
    s_mov_b32 s40, s44
    s_mov_b32 s41, s45
    s_mov_b32 s42, 10821632
    s_mov_b32 s43, 0x00020000
    buffer_load_ushort v6, v7, s[32:35], 0 offen
    buffer_load_ushort v2, v1, s[16:19], 0 offen
    buffer_load_ushort v3, v1, s[20:23], 0 offen
    buffer_load_ushort v4, v1, s[24:27], 0 offen
    buffer_load_ushort v5, v1, s[28:31], 0 offen
    buffer_load_ushort v96, v7, s[36:39], 0 offen
    s_barrier
    s_waitcnt vmcnt(5)
    v_lshlrev_b32 v6, 16, v6
    v_mul_f32 v8, s60, v6
    v_fma_f32 v9, v6, s60, -v8
    v_fmac_f32 v9, s61, v6
    v_exp_f32 v8, v8
    v_mul_f32 v9, s62, v9
    v_fma_f32 v6, v8, v9, v8
    v_cvt_pk_bf16_f32 v6, v6, v6
    v_lshlrev_b32 v6, 16, v6
    s_waitcnt vmcnt(4)
    v_lshlrev_b32 v2, 16, v2
    v_mul_f32 v8, s60, v2
    v_fma_f32 v9, v2, s60, -v8
    v_fmac_f32 v9, s61, v2
    v_exp_f32 v8, v8
    v_mul_f32 v9, s62, v9
    v_fma_f32 v2, v8, v9, v8
    v_cvt_pk_bf16_f32 v2, v2, v2
    v_lshlrev_b32 v2, 16, v2
    s_waitcnt vmcnt(1)
    v_lshlrev_b32 v3, 16, v3
    v_lshlrev_b32 v4, 16, v4
    v_lshlrev_b32 v5, 16, v5
    v_mul_f32 v2, v2, v6
    v_mul_f32 v3, v3, v6
    v_add_f32 v6, v6, v6
    v_mul_f32 v2, 0xbfb8aa3b, v2
    v_mul_f32 v3, 0.15915494, v3
    v_mul_f32 v4, v4, v6
    v_mul_f32 v5, v5, v6
    v_mul_f32 v8, 1.0, v2
    v_mul_f32 v9, 1.0, v3
    v_exp_f32 v8, v8
    v_fract_f32 v9, v9
    v_cos_f32 v12, v9
    v_sin_f32 v13, v9
    s_nop 0
    v_pk_mul_f32 v[12:13], v[12:13], v[8:9] op_sel_hi:[1,0]
    v_mul_f32 v8, 0x41000000, v2
    v_mul_f32 v9, 0x41000000, v3
    v_exp_f32 v8, v8
    v_fract_f32 v9, v9
    v_cos_f32 v18, v9
    v_sin_f32 v19, v9
    s_nop 0
    v_pk_mul_f32 v[18:19], v[18:19], v[8:9] op_sel_hi:[1,0]
    v_mul_f32 v8, 0x43000000, v2
    v_mul_f32 v9, 0x43000000, v3
    v_exp_f32 v8, v8
    v_fract_f32 v9, v9
    v_cos_f32 v20, v9
    v_sin_f32 v21, v9
    s_nop 0
    v_pk_mul_f32 v[20:21], v[20:21], v[8:9] op_sel_hi:[1,0]
    v_mul_f32 v8, 0x44800000, v2
    v_mul_f32 v9, 0x44800000, v3
    v_exp_f32 v8, v8
    v_fract_f32 v9, v9
    v_cos_f32 v28, v9
    v_sin_f32 v29, v9
    s_nop 0
    v_pk_mul_f32 v[28:29], v[28:29], v[8:9] op_sel_hi:[1,0]
    v_cvt_pk_bf16_f32 v48, v4, -v5
    ds_write_addtid_b32 v48 offset:0
    v_pk_mul_f32 v[46:47], v[4:5], v[18:19] op_sel:[1,1] op_sel_hi:[1,0] neg_lo:[1,0]
    v_pk_fma_f32 v[44:45], v[4:5], v[18:19], v[46:47] op_sel:[0,0,0] op_sel_hi:[0,1,1]
    v_cvt_pk_bf16_f32 v48, v44, -v45
    ds_write_addtid_b32 v48 offset:288
    v_pk_mul_f32 v[46:47], v[44:45], v[18:19] op_sel:[1,1] op_sel_hi:[1,0] neg_lo:[1,0]
    v_pk_fma_f32 v[44:45], v[44:45], v[18:19], v[46:47] op_sel:[0,0,0] op_sel_hi:[0,1,1]
    v_cvt_pk_bf16_f32 v48, v44, -v45
    ds_write_addtid_b32 v48 offset:576
    v_pk_mul_f32 v[46:47], v[44:45], v[18:19] op_sel:[1,1] op_sel_hi:[1,0] neg_lo:[1,0]
    v_pk_fma_f32 v[44:45], v[44:45], v[18:19], v[46:47] op_sel:[0,0,0] op_sel_hi:[0,1,1]
    v_cvt_pk_bf16_f32 v48, v44, -v45
    ds_write_addtid_b32 v48 offset:864
    v_pk_mul_f32 v[46:47], v[44:45], v[18:19] op_sel:[1,1] op_sel_hi:[1,0] neg_lo:[1,0]
    v_pk_fma_f32 v[44:45], v[44:45], v[18:19], v[46:47] op_sel:[0,0,0] op_sel_hi:[0,1,1]
    v_cvt_pk_bf16_f32 v48, v44, -v45
    ds_write_addtid_b32 v48 offset:1152
    v_pk_mul_f32 v[46:47], v[44:45], v[18:19] op_sel:[1,1] op_sel_hi:[1,0] neg_lo:[1,0]
    v_pk_fma_f32 v[44:45], v[44:45], v[18:19], v[46:47] op_sel:[0,0,0] op_sel_hi:[0,1,1]
    v_cvt_pk_bf16_f32 v48, v44, -v45
    ds_write_addtid_b32 v48 offset:1440
    v_pk_mul_f32 v[46:47], v[44:45], v[18:19] op_sel:[1,1] op_sel_hi:[1,0] neg_lo:[1,0]
    v_pk_fma_f32 v[44:45], v[44:45], v[18:19], v[46:47] op_sel:[0,0,0] op_sel_hi:[0,1,1]
    v_cvt_pk_bf16_f32 v48, v44, -v45
    ds_write_addtid_b32 v48 offset:1728
    v_pk_mul_f32 v[46:47], v[44:45], v[18:19] op_sel:[1,1] op_sel_hi:[1,0] neg_lo:[1,0]
    v_pk_fma_f32 v[44:45], v[44:45], v[18:19], v[46:47] op_sel:[0,0,0] op_sel_hi:[0,1,1]
    v_cvt_pk_bf16_f32 v48, v44, -v45
    ds_write_addtid_b32 v48 offset:2016
    v_pk_mul_f32 v[46:47], v[44:45], v[18:19] op_sel:[1,1] op_sel_hi:[1,0] neg_lo:[1,0]
    v_pk_fma_f32 v[44:45], v[44:45], v[18:19], v[46:47] op_sel:[0,0,0] op_sel_hi:[0,1,1]
    v_cvt_pk_bf16_f32 v48, v44, -v45
    ds_write_addtid_b32 v48 offset:2304
    v_pk_mul_f32 v[46:47], v[44:45], v[18:19] op_sel:[1,1] op_sel_hi:[1,0] neg_lo:[1,0]
    v_pk_fma_f32 v[44:45], v[44:45], v[18:19], v[46:47] op_sel:[0,0,0] op_sel_hi:[0,1,1]
    v_cvt_pk_bf16_f32 v48, v44, -v45
    ds_write_addtid_b32 v48 offset:2592
    v_pk_mul_f32 v[46:47], v[44:45], v[18:19] op_sel:[1,1] op_sel_hi:[1,0] neg_lo:[1,0]
    v_pk_fma_f32 v[44:45], v[44:45], v[18:19], v[46:47] op_sel:[0,0,0] op_sel_hi:[0,1,1]
    v_cvt_pk_bf16_f32 v48, v44, -v45
    ds_write_addtid_b32 v48 offset:2880
    v_pk_mul_f32 v[46:47], v[44:45], v[18:19] op_sel:[1,1] op_sel_hi:[1,0] neg_lo:[1,0]
    v_pk_fma_f32 v[44:45], v[44:45], v[18:19], v[46:47] op_sel:[0,0,0] op_sel_hi:[0,1,1]
    v_cvt_pk_bf16_f32 v48, v44, -v45
    ds_write_addtid_b32 v48 offset:3168
    v_pk_mul_f32 v[46:47], v[44:45], v[18:19] op_sel:[1,1] op_sel_hi:[1,0] neg_lo:[1,0]
    v_pk_fma_f32 v[44:45], v[44:45], v[18:19], v[46:47] op_sel:[0,0,0] op_sel_hi:[0,1,1]
    v_cvt_pk_bf16_f32 v48, v44, -v45
    ds_write_addtid_b32 v48 offset:3456
    v_pk_mul_f32 v[46:47], v[44:45], v[18:19] op_sel:[1,1] op_sel_hi:[1,0] neg_lo:[1,0]
    v_pk_fma_f32 v[44:45], v[44:45], v[18:19], v[46:47] op_sel:[0,0,0] op_sel_hi:[0,1,1]
    v_cvt_pk_bf16_f32 v48, v44, -v45
    ds_write_addtid_b32 v48 offset:3744
    v_pk_mul_f32 v[46:47], v[44:45], v[18:19] op_sel:[1,1] op_sel_hi:[1,0] neg_lo:[1,0]
    v_pk_fma_f32 v[44:45], v[44:45], v[18:19], v[46:47] op_sel:[0,0,0] op_sel_hi:[0,1,1]
    v_cvt_pk_bf16_f32 v48, v44, -v45
    ds_write_addtid_b32 v48 offset:4032
    v_pk_mul_f32 v[46:47], v[44:45], v[18:19] op_sel:[1,1] op_sel_hi:[1,0] neg_lo:[1,0]
    v_pk_fma_f32 v[44:45], v[44:45], v[18:19], v[46:47] op_sel:[0,0,0] op_sel_hi:[0,1,1]
    v_cvt_pk_bf16_f32 v48, v44, -v45
    ds_write_addtid_b32 v48 offset:4320
    ds_read_b128 v[52:55], v50 offset:0
    ds_read_b128 v[56:59], v50 offset:64
    ds_read_b128 v[60:63], v50 offset:128
    ds_read_b128 v[64:67], v50 offset:192
    v_pk_mul_f32 v[46:47], v[12:13], v[12:13] op_sel:[1,1] op_sel_hi:[1,0] neg_lo:[1,0]
    v_pk_fma_f32 v[14:15], v[12:13], v[12:13], v[46:47] op_sel:[0,0,0] op_sel_hi:[0,1,1]
    v_pk_mul_f32 v[46:47], v[14:15], v[14:15] op_sel:[1,1] op_sel_hi:[1,0] neg_lo:[1,0]
    v_pk_fma_f32 v[16:17], v[14:15], v[14:15], v[46:47] op_sel:[0,0,0] op_sel_hi:[0,1,1]
    v_pk_mul_f32 v[46:47], v[14:15], v[12:13] op_sel:[1,1] op_sel_hi:[1,0] neg_lo:[1,0]
    v_pk_fma_f32 v[30:31], v[14:15], v[12:13], v[46:47] op_sel:[0,0,0] op_sel_hi:[0,1,1]
    v_pk_mul_f32 v[46:47], v[16:17], v[12:13] op_sel:[1,1] op_sel_hi:[1,0] neg_lo:[1,0]
    v_pk_fma_f32 v[32:33], v[16:17], v[12:13], v[46:47] op_sel:[0,0,0] op_sel_hi:[0,1,1]
    v_pk_mul_f32 v[46:47], v[16:17], v[14:15] op_sel:[1,1] op_sel_hi:[1,0] neg_lo:[1,0]
    v_pk_fma_f32 v[34:35], v[16:17], v[14:15], v[46:47] op_sel:[0,0,0] op_sel_hi:[0,1,1]
    v_pk_mul_f32 v[46:47], v[16:17], v[30:31] op_sel:[1,1] op_sel_hi:[1,0] neg_lo:[1,0]
    v_pk_fma_f32 v[36:37], v[16:17], v[30:31], v[46:47] op_sel:[0,0,0] op_sel_hi:[0,1,1]
    v_mov_b32 v48, 0x00003f80
    ds_write_addtid_b32 v48 offset:0
    v_cvt_pk_bf16_f32 v48, v12, v13
    ds_write_addtid_b32 v48 offset:288
    v_cvt_pk_bf16_f32 v48, v14, v15
    ds_write_addtid_b32 v48 offset:576
    v_cvt_pk_bf16_f32 v48, v30, v31
    ds_write_addtid_b32 v48 offset:864
    v_cvt_pk_bf16_f32 v48, v16, v17
    ds_write_addtid_b32 v48 offset:1152
    v_cvt_pk_bf16_f32 v48, v32, v33
    ds_write_addtid_b32 v48 offset:1440
    v_cvt_pk_bf16_f32 v48, v34, v35
    ds_write_addtid_b32 v48 offset:1728
    v_cvt_pk_bf16_f32 v48, v36, v37
    ds_write_addtid_b32 v48 offset:2016
    v_cvt_pk_bf16_f32 v48, v20, v21
    ds_write_addtid_b32 v48 offset:2304
    v_pk_mul_f32 v[46:47], v[12:13], v[20:21] op_sel:[1,1] op_sel_hi:[1,0] neg_lo:[1,0]
    v_pk_fma_f32 v[44:45], v[12:13], v[20:21], v[46:47] op_sel:[0,0,0] op_sel_hi:[0,1,1]
    v_cvt_pk_bf16_f32 v48, v44, v45
    ds_write_addtid_b32 v48 offset:2592
    v_pk_mul_f32 v[46:47], v[14:15], v[20:21] op_sel:[1,1] op_sel_hi:[1,0] neg_lo:[1,0]
    v_pk_fma_f32 v[38:39], v[14:15], v[20:21], v[46:47] op_sel:[0,0,0] op_sel_hi:[0,1,1]
    v_cvt_pk_bf16_f32 v48, v38, v39
    ds_write_addtid_b32 v48 offset:2880
    v_pk_mul_f32 v[46:47], v[30:31], v[20:21] op_sel:[1,1] op_sel_hi:[1,0] neg_lo:[1,0]
    v_pk_fma_f32 v[44:45], v[30:31], v[20:21], v[46:47] op_sel:[0,0,0] op_sel_hi:[0,1,1]
    v_cvt_pk_bf16_f32 v48, v44, v45
    ds_write_addtid_b32 v48 offset:3168
    v_pk_mul_f32 v[46:47], v[16:17], v[20:21] op_sel:[1,1] op_sel_hi:[1,0] neg_lo:[1,0]
    v_pk_fma_f32 v[40:41], v[16:17], v[20:21], v[46:47] op_sel:[0,0,0] op_sel_hi:[0,1,1]
    v_cvt_pk_bf16_f32 v48, v40, v41
    ds_write_addtid_b32 v48 offset:3456
    v_pk_mul_f32 v[46:47], v[32:33], v[20:21] op_sel:[1,1] op_sel_hi:[1,0] neg_lo:[1,0]
    v_pk_fma_f32 v[44:45], v[32:33], v[20:21], v[46:47] op_sel:[0,0,0] op_sel_hi:[0,1,1]
    v_cvt_pk_bf16_f32 v48, v44, v45
    ds_write_addtid_b32 v48 offset:3744
    v_pk_mul_f32 v[46:47], v[34:35], v[20:21] op_sel:[1,1] op_sel_hi:[1,0] neg_lo:[1,0]
    v_pk_fma_f32 v[42:43], v[34:35], v[20:21], v[46:47] op_sel:[0,0,0] op_sel_hi:[0,1,1]
    v_cvt_pk_bf16_f32 v48, v42, v43
    ds_write_addtid_b32 v48 offset:4032
    v_pk_mul_f32 v[46:47], v[36:37], v[20:21] op_sel:[1,1] op_sel_hi:[1,0] neg_lo:[1,0]
    v_pk_fma_f32 v[44:45], v[36:37], v[20:21], v[46:47] op_sel:[0,0,0] op_sel_hi:[0,1,1]
    v_cvt_pk_bf16_f32 v48, v44, v45
    ds_write_addtid_b32 v48 offset:4320
    ds_read_b128 v[68:71], v50 offset:0
    ds_read_b128 v[72:75], v50 offset:64
    ds_read_b128 v[76:79], v50 offset:128
    ds_read_b128 v[80:83], v50 offset:192
    v_pk_mul_f32 v[46:47], v[20:21], v[20:21] op_sel:[1,1] op_sel_hi:[1,0] neg_lo:[1,0]
    v_pk_fma_f32 v[22:23], v[20:21], v[20:21], v[46:47] op_sel:[0,0,0] op_sel_hi:[0,1,1]
    v_pk_mul_f32 v[46:47], v[22:23], v[22:23] op_sel:[1,1] op_sel_hi:[1,0] neg_lo:[1,0]
    v_pk_fma_f32 v[24:25], v[22:23], v[22:23], v[46:47] op_sel:[0,0,0] op_sel_hi:[0,1,1]
    v_pk_mul_f32 v[46:47], v[24:25], v[22:23] op_sel:[1,1] op_sel_hi:[1,0] neg_lo:[1,0]
    v_pk_fma_f32 v[26:27], v[24:25], v[22:23], v[46:47] op_sel:[0,0,0] op_sel_hi:[0,1,1]
    s_waitcnt lgkmcnt(0)
    v_mfma_f32_16x16x32_bf16 v[84:87], v[68:71], v[52:55], 0
    v_mfma_f32_16x16x32_bf16 v[84:87], v[72:75], v[56:59], v[84:87]
    v_mfma_f32_16x16x32_bf16 v[84:87], v[76:79], v[60:63], v[84:87]
    v_mfma_f32_16x16x32_bf16 v[84:87], v[80:83], v[64:67], v[84:87]
    v_cvt_pk_bf16_f32 v48, v22, v23
    ds_write_addtid_b32 v48 offset:0
    v_pk_mul_f32 v[46:47], v[14:15], v[22:23] op_sel:[1,1] op_sel_hi:[1,0] neg_lo:[1,0]
    v_pk_fma_f32 v[44:45], v[14:15], v[22:23], v[46:47] op_sel:[0,0,0] op_sel_hi:[0,1,1]
    v_cvt_pk_bf16_f32 v48, v44, v45
    ds_write_addtid_b32 v48 offset:288
    v_pk_mul_f32 v[46:47], v[16:17], v[22:23] op_sel:[1,1] op_sel_hi:[1,0] neg_lo:[1,0]
    v_pk_fma_f32 v[44:45], v[16:17], v[22:23], v[46:47] op_sel:[0,0,0] op_sel_hi:[0,1,1]
    v_cvt_pk_bf16_f32 v48, v44, v45
    ds_write_addtid_b32 v48 offset:576
    v_pk_mul_f32 v[46:47], v[34:35], v[22:23] op_sel:[1,1] op_sel_hi:[1,0] neg_lo:[1,0]
    v_pk_fma_f32 v[44:45], v[34:35], v[22:23], v[46:47] op_sel:[0,0,0] op_sel_hi:[0,1,1]
    v_cvt_pk_bf16_f32 v48, v44, v45
    ds_write_addtid_b32 v48 offset:864
    v_pk_mul_f32 v[46:47], v[20:21], v[22:23] op_sel:[1,1] op_sel_hi:[1,0] neg_lo:[1,0]
    v_pk_fma_f32 v[44:45], v[20:21], v[22:23], v[46:47] op_sel:[0,0,0] op_sel_hi:[0,1,1]
    v_cvt_pk_bf16_f32 v48, v44, v45
    ds_write_addtid_b32 v48 offset:1152
    v_pk_mul_f32 v[46:47], v[38:39], v[22:23] op_sel:[1,1] op_sel_hi:[1,0] neg_lo:[1,0]
    v_pk_fma_f32 v[44:45], v[38:39], v[22:23], v[46:47] op_sel:[0,0,0] op_sel_hi:[0,1,1]
    v_cvt_pk_bf16_f32 v48, v44, v45
    ds_write_addtid_b32 v48 offset:1440
    v_pk_mul_f32 v[46:47], v[40:41], v[22:23] op_sel:[1,1] op_sel_hi:[1,0] neg_lo:[1,0]
    v_pk_fma_f32 v[44:45], v[40:41], v[22:23], v[46:47] op_sel:[0,0,0] op_sel_hi:[0,1,1]
    v_cvt_pk_bf16_f32 v48, v44, v45
    ds_write_addtid_b32 v48 offset:1728
    v_pk_mul_f32 v[46:47], v[42:43], v[22:23] op_sel:[1,1] op_sel_hi:[1,0] neg_lo:[1,0]
    v_pk_fma_f32 v[44:45], v[42:43], v[22:23], v[46:47] op_sel:[0,0,0] op_sel_hi:[0,1,1]
    v_cvt_pk_bf16_f32 v48, v44, v45
    ds_write_addtid_b32 v48 offset:2016
    v_cvt_pk_bf16_f32 v48, v24, v25
    ds_write_addtid_b32 v48 offset:2304
    v_pk_mul_f32 v[46:47], v[16:17], v[24:25] op_sel:[1,1] op_sel_hi:[1,0] neg_lo:[1,0]
    v_pk_fma_f32 v[44:45], v[16:17], v[24:25], v[46:47] op_sel:[0,0,0] op_sel_hi:[0,1,1]
    v_cvt_pk_bf16_f32 v48, v44, v45
    ds_write_addtid_b32 v48 offset:2592
    v_pk_mul_f32 v[46:47], v[20:21], v[24:25] op_sel:[1,1] op_sel_hi:[1,0] neg_lo:[1,0]
    v_pk_fma_f32 v[44:45], v[20:21], v[24:25], v[46:47] op_sel:[0,0,0] op_sel_hi:[0,1,1]
    v_cvt_pk_bf16_f32 v48, v44, v45
    ds_write_addtid_b32 v48 offset:2880
    v_pk_mul_f32 v[46:47], v[40:41], v[24:25] op_sel:[1,1] op_sel_hi:[1,0] neg_lo:[1,0]
    v_pk_fma_f32 v[44:45], v[40:41], v[24:25], v[46:47] op_sel:[0,0,0] op_sel_hi:[0,1,1]
    v_cvt_pk_bf16_f32 v48, v44, v45
    ds_write_addtid_b32 v48 offset:3168
    v_cvt_pk_bf16_f32 v48, v26, v27
    ds_write_addtid_b32 v48 offset:3456
    v_pk_mul_f32 v[46:47], v[16:17], v[26:27] op_sel:[1,1] op_sel_hi:[1,0] neg_lo:[1,0]
    v_pk_fma_f32 v[44:45], v[16:17], v[26:27], v[46:47] op_sel:[0,0,0] op_sel_hi:[0,1,1]
    v_cvt_pk_bf16_f32 v48, v44, v45
    ds_write_addtid_b32 v48 offset:3744
    v_pk_mul_f32 v[46:47], v[20:21], v[26:27] op_sel:[1,1] op_sel_hi:[1,0] neg_lo:[1,0]
    v_pk_fma_f32 v[44:45], v[20:21], v[26:27], v[46:47] op_sel:[0,0,0] op_sel_hi:[0,1,1]
    v_cvt_pk_bf16_f32 v48, v44, v45
    ds_write_addtid_b32 v48 offset:4032
    v_pk_mul_f32 v[46:47], v[40:41], v[26:27] op_sel:[1,1] op_sel_hi:[1,0] neg_lo:[1,0]
    v_pk_fma_f32 v[44:45], v[40:41], v[26:27], v[46:47] op_sel:[0,0,0] op_sel_hi:[0,1,1]
    v_cvt_pk_bf16_f32 v48, v44, v45
    ds_write_addtid_b32 v48 offset:4320
    ds_read_b128 v[68:71], v50 offset:0
    ds_read_b128 v[72:75], v50 offset:64
    ds_read_b128 v[76:79], v50 offset:128
    ds_read_b128 v[80:83], v50 offset:192
    v_cvt_pk_bf16_f32 v30, v28, v29
    v_pk_mul_f32 v[46:47], v[28:29], v[20:21] op_sel:[1,1] op_sel_hi:[1,0] neg_lo:[1,0]
    v_pk_fma_f32 v[28:29], v[28:29], v[20:21], v[46:47] op_sel:[0,0,0] op_sel_hi:[0,1,1]
    v_cvt_pk_bf16_f32 v31, v28, v29
    v_pk_mul_f32 v[46:47], v[28:29], v[20:21] op_sel:[1,1] op_sel_hi:[1,0] neg_lo:[1,0]
    v_pk_fma_f32 v[28:29], v[28:29], v[20:21], v[46:47] op_sel:[0,0,0] op_sel_hi:[0,1,1]
    v_cvt_pk_bf16_f32 v32, v28, v29
    v_pk_mul_f32 v[46:47], v[28:29], v[20:21] op_sel:[1,1] op_sel_hi:[1,0] neg_lo:[1,0]
    v_pk_fma_f32 v[28:29], v[28:29], v[20:21], v[46:47] op_sel:[0,0,0] op_sel_hi:[0,1,1]
    v_cvt_pk_bf16_f32 v33, v28, v29
    v_pk_mul_f32 v[46:47], v[28:29], v[20:21] op_sel:[1,1] op_sel_hi:[1,0] neg_lo:[1,0]
    v_pk_fma_f32 v[28:29], v[28:29], v[20:21], v[46:47] op_sel:[0,0,0] op_sel_hi:[0,1,1]
    v_cvt_pk_bf16_f32 v34, v28, v29
    v_pk_mul_f32 v[46:47], v[28:29], v[20:21] op_sel:[1,1] op_sel_hi:[1,0] neg_lo:[1,0]
    v_pk_fma_f32 v[28:29], v[28:29], v[20:21], v[46:47] op_sel:[0,0,0] op_sel_hi:[0,1,1]
    v_cvt_pk_bf16_f32 v35, v28, v29
    v_pk_mul_f32 v[46:47], v[28:29], v[20:21] op_sel:[1,1] op_sel_hi:[1,0] neg_lo:[1,0]
    v_pk_fma_f32 v[28:29], v[28:29], v[20:21], v[46:47] op_sel:[0,0,0] op_sel_hi:[0,1,1]
    v_cvt_pk_bf16_f32 v36, v28, v29
    v_pk_mul_f32 v[46:47], v[28:29], v[20:21] op_sel:[1,1] op_sel_hi:[1,0] neg_lo:[1,0]
    v_pk_fma_f32 v[28:29], v[28:29], v[20:21], v[46:47] op_sel:[0,0,0] op_sel_hi:[0,1,1]
    v_cvt_pk_bf16_f32 v37, v28, v29
    v_pk_mul_f32 v[46:47], v[28:29], v[20:21] op_sel:[1,1] op_sel_hi:[1,0] neg_lo:[1,0]
    v_pk_fma_f32 v[28:29], v[28:29], v[20:21], v[46:47] op_sel:[0,0,0] op_sel_hi:[0,1,1]
    v_cvt_pk_bf16_f32 v38, v28, v29
    s_waitcnt lgkmcnt(0)
    v_mfma_f32_16x16x32_bf16 v[88:91], v[68:71], v[52:55], 0
    v_mfma_f32_16x16x32_bf16 v[88:91], v[72:75], v[56:59], v[88:91]
    v_mfma_f32_16x16x32_bf16 v[88:91], v[76:79], v[60:63], v[88:91]
    v_mfma_f32_16x16x32_bf16 v[88:91], v[80:83], v[64:67], v[88:91]
    ds_write_addtid_b32 v30 offset:0
    ds_write_addtid_b32 v31 offset:288
    ds_write_addtid_b32 v32 offset:576
    ds_write_addtid_b32 v33 offset:864
    ds_write_addtid_b32 v34 offset:1152
    ds_write_addtid_b32 v35 offset:1440
    ds_write_addtid_b32 v36 offset:1728
    ds_write_addtid_b32 v37 offset:2016
    ds_write_addtid_b32 v38 offset:2304
    ds_read_b128 v[68:71], v50 offset:0
    ds_read_b128 v[72:75], v50 offset:64
    ds_read_b128 v[76:79], v50 offset:128
    ds_read_b128 v[80:83], v50 offset:192
    s_waitcnt lgkmcnt(0)
    v_mfma_f32_16x16x32_bf16 v[92:95], v[68:71], v[52:55], 0
    v_mfma_f32_16x16x32_bf16 v[92:95], v[72:75], v[56:59], v[92:95]
    v_mfma_f32_16x16x32_bf16 v[92:95], v[76:79], v[60:63], v[92:95]
    v_mfma_f32_16x16x32_bf16 v[92:95], v[80:83], v[64:67], v[92:95]
    v_lshlrev_b32 v8, 4, v100
    v_add_u32 v8, s54, v8
    s_lshl_b32 s57, s56, 3
    s_add_u32 s57, s57, 8
    s_nop 5
    ds_write_b128 v8, v[84:87]
    ds_write_b128 v8, v[88:91] offset:1024
    ds_write_b128 v8, v[92:95] offset:2048
    s_waitcnt lgkmcnt(0)
    v_mov_b32 v10, s57
    v_mov_b32 v11, 1
    s_mov_b64 exec, 1
    ds_add_u32 v10, v11
    s_mov_b64 exec, -1
    s_mov_b32 s64, 0x40000
L_gs_4:
    ds_read_b32 v11, v10
    s_waitcnt lgkmcnt(0)
    v_readfirstlane_b32 s63, v11
    s_sub_u32 s64, s64, 1
    s_cbranch_scc1 L_gs_4_done
    s_cmp_ge_u32 s63, 3
    s_cbranch_scc1 L_gs_4_done
    s_sleep 1
    s_branch L_gs_4
L_gs_4_done:
    v_lshlrev_b32 v8, 4, v100
    s_lshl_b32 s58, s55, 10
    s_add_u32 s58, s58, s49
    v_add_u32 v8, s58, v8
    ds_read_b128 v[12:15], v8
    ds_read_b128 v[16:19], v8 offset:4608
    ds_read_b128 v[20:23], v8 offset:9216
    s_mul_i32 s53, s50, 1536
    s_lshl_b32 s59, s55, 9
    s_add_u32 s53, s53, s59
    s_add_u32 s53, s53, 5406720
    v_lshlrev_b32 v1, 3, v100
    s_waitcnt vmcnt(0)
    v_lshlrev_b32 v96, 16, v96
    v_cmp_eq_u32 vcc, 0, v100
    s_cmp_eq_u32 s55, 0
    s_cselect_b32 s59, -1, 0
    v_mov_b32 v9, 0
    v_cndmask_b32 v96, v9, v96, vcc
    v_and_b32 v96, s59, v96
    s_waitcnt lgkmcnt(0)
    v_pk_add_f32 v[12:13], v[12:13], v[16:17]
    v_pk_add_f32 v[14:15], v[14:15], v[18:19]
    v_pk_add_f32 v[12:13], v[12:13], v[20:21]
    v_pk_add_f32 v[14:15], v[14:15], v[22:23]
    v_add_f32 v12, v12, v96
    v_cvt_pk_bf16_f32 v14, v14, v15
    v_cvt_pk_bf16_f32 v13, v12, v13
    v_mov_b32 v15, v14
    v_mov_b32 v14, v13
    buffer_store_dwordx2 v[14:15], v1, s[40:43], s53 offen sc1
    s_endpgm
L_k1_misc:
    s_cmp_eq_u32 s51, 15
    s_cbranch_scc1 L_k1_pf
    s_load_dwordx2 s[64:65], s[0:1], 0
    s_load_dwordx2 s[66:67], s[0:1], 104
    s_setprio 0
    s_and_b32 s36, s2, 7
    s_lshr_b32 s37, s2, 3
    s_lshr_b32 s38, s37, 3
    s_lshl_b32 s38, s38, 3
    s_add_u32 s38, s38, s36
    s_lshl_b32 s38, s38, 6
    s_and_b32 s37, s37, 7
    s_lshl_b32 s37, s37, 3
    s_add_u32 s38, s38, s37
    s_mul_i32 s39, s38, 1280
    v_lshlrev_b32 v1, 4, v100
    v_add_u32 v2, s39, v1
    v_add_u32 v3, 1024, v1
    v_add_u32 v4, 1024, v2
    v_cmp_gt_u32 vcc, 16, v100
    v_mov_b32 v5, 0x80000000
    s_waitcnt lgkmcnt(0)
    v_cndmask_b32 v4, v5, v4, vcc
    s_mov_b32 s16, s64
    s_mov_b32 s17, s65
    s_mov_b32 s18, 2621440
    s_mov_b32 s19, 0x00020000
    s_mov_b32 s20, s66
    s_mov_b32 s21, s67
    s_mov_b32 s22, 1280
    s_mov_b32 s23, 0x00020000
    s_mov_b32 s40, s44
    s_mov_b32 s41, s45
    s_mov_b32 s42, 10821632
    s_mov_b32 s43, 0x00020000
    s_barrier
    buffer_load_dwordx4 v[8:11], v1, s[20:23], 0 offen
    buffer_load_dwordx4 v[12:15], v3, s[20:23], 0 offen
    s_movk_i32 s68, 0
    buffer_load_dwordx4 v[16:19], v2, s[16:19], s68 offen
    buffer_load_dwordx4 v[20:23], v4, s[16:19], s68 offen
    s_movk_i32 s68, 1280
    buffer_load_dwordx4 v[24:27], v2, s[16:19], s68 offen
    buffer_load_dwordx4 v[28:31], v4, s[16:19], s68 offen
    s_movk_i32 s68, 2560
    buffer_load_dwordx4 v[32:35], v2, s[16:19], s68 offen
    buffer_load_dwordx4 v[36:39], v4, s[16:19], s68 offen
    s_movk_i32 s68, 3840
    buffer_load_dwordx4 v[40:43], v2, s[16:19], s68 offen
    buffer_load_dwordx4 v[44:47], v4, s[16:19], s68 offen
    s_movk_i32 s68, 5120
    buffer_load_dwordx4 v[48:51], v2, s[16:19], s68 offen
    buffer_load_dwordx4 v[52:55], v4, s[16:19], s68 offen
    s_movk_i32 s68, 6400
    buffer_load_dwordx4 v[56:59], v2, s[16:19], s68 offen
    buffer_load_dwordx4 v[60:63], v4, s[16:19], s68 offen
    s_movk_i32 s68, 7680
    buffer_load_dwordx4 v[64:67], v2, s[16:19], s68 offen
    buffer_load_dwordx4 v[68:71], v4, s[16:19], s68 offen
    s_movk_i32 s68, 8960
    buffer_load_dwordx4 v[72:75], v2, s[16:19], s68 offen
    buffer_load_dwordx4 v[76:79], v4, s[16:19], s68 offen
    v_mov_b32 v84, 0
    v_mov_b32 v85, 0
    v_mov_b32 v86, 0
    v_mov_b32 v87, 0
    v_mov_b32 v88, 0
    v_mov_b32 v89, 0
    v_mov_b32 v90, 0
    v_mov_b32 v91, 0
    s_waitcnt vmcnt(14)
    v_dot2_f32_bf16 v84, v16, v8, v84
    v_dot2_f32_bf16 v84, v17, v9, v84
    v_dot2_f32_bf16 v84, v18, v10, v84
    v_dot2_f32_bf16 v84, v19, v11, v84
    v_dot2_f32_bf16 v84, v20, v12, v84
    v_dot2_f32_bf16 v84, v21, v13, v84
    v_dot2_f32_bf16 v84, v22, v14, v84
    v_dot2_f32_bf16 v84, v23, v15, v84
    s_waitcnt vmcnt(12)
    v_dot2_f32_bf16 v85, v24, v8, v85
    v_dot2_f32_bf16 v85, v25, v9, v85
    v_dot2_f32_bf16 v85, v26, v10, v85
    v_dot2_f32_bf16 v85, v27, v11, v85
    v_dot2_f32_bf16 v85, v28, v12, v85
    v_dot2_f32_bf16 v85, v29, v13, v85
    v_dot2_f32_bf16 v85, v30, v14, v85
    v_dot2_f32_bf16 v85, v31, v15, v85
    s_waitcnt vmcnt(10)
    v_dot2_f32_bf16 v86, v32, v8, v86
    v_dot2_f32_bf16 v86, v33, v9, v86
    v_dot2_f32_bf16 v86, v34, v10, v86
    v_dot2_f32_bf16 v86, v35, v11, v86
    v_dot2_f32_bf16 v86, v36, v12, v86
    v_dot2_f32_bf16 v86, v37, v13, v86
    v_dot2_f32_bf16 v86, v38, v14, v86
    v_dot2_f32_bf16 v86, v39, v15, v86
    s_waitcnt vmcnt(8)
    v_dot2_f32_bf16 v87, v40, v8, v87
    v_dot2_f32_bf16 v87, v41, v9, v87
    v_dot2_f32_bf16 v87, v42, v10, v87
    v_dot2_f32_bf16 v87, v43, v11, v87
    v_dot2_f32_bf16 v87, v44, v12, v87
    v_dot2_f32_bf16 v87, v45, v13, v87
    v_dot2_f32_bf16 v87, v46, v14, v87
    v_dot2_f32_bf16 v87, v47, v15, v87
    s_waitcnt vmcnt(6)
    v_dot2_f32_bf16 v88, v48, v8, v88
    v_dot2_f32_bf16 v88, v49, v9, v88
    v_dot2_f32_bf16 v88, v50, v10, v88
    v_dot2_f32_bf16 v88, v51, v11, v88
    v_dot2_f32_bf16 v88, v52, v12, v88
    v_dot2_f32_bf16 v88, v53, v13, v88
    v_dot2_f32_bf16 v88, v54, v14, v88
    v_dot2_f32_bf16 v88, v55, v15, v88
    s_waitcnt vmcnt(4)
    v_dot2_f32_bf16 v89, v56, v8, v89
    v_dot2_f32_bf16 v89, v57, v9, v89
    v_dot2_f32_bf16 v89, v58, v10, v89
    v_dot2_f32_bf16 v89, v59, v11, v89
    v_dot2_f32_bf16 v89, v60, v12, v89
    v_dot2_f32_bf16 v89, v61, v13, v89
    v_dot2_f32_bf16 v89, v62, v14, v89
    v_dot2_f32_bf16 v89, v63, v15, v89
    s_waitcnt vmcnt(2)
    v_dot2_f32_bf16 v90, v64, v8, v90
    v_dot2_f32_bf16 v90, v65, v9, v90
    v_dot2_f32_bf16 v90, v66, v10, v90
    v_dot2_f32_bf16 v90, v67, v11, v90
    v_dot2_f32_bf16 v90, v68, v12, v90
    v_dot2_f32_bf16 v90, v69, v13, v90
    v_dot2_f32_bf16 v90, v70, v14, v90
    v_dot2_f32_bf16 v90, v71, v15, v90
    s_waitcnt vmcnt(0)
    v_dot2_f32_bf16 v91, v72, v8, v91
    v_dot2_f32_bf16 v91, v73, v9, v91
    v_dot2_f32_bf16 v91, v74, v10, v91
    v_dot2_f32_bf16 v91, v75, v11, v91
    v_dot2_f32_bf16 v91, v76, v12, v91
    v_dot2_f32_bf16 v91, v77, v13, v91
    v_dot2_f32_bf16 v91, v78, v14, v91
    v_dot2_f32_bf16 v91, v79, v15, v91
    s_nop 2
    v_add_f32_dpp v84, v84, v84 row_shr:1 row_mask:0xf bank_mask:0xf
    v_add_f32_dpp v85, v85, v85 row_shr:1 row_mask:0xf bank_mask:0xf
    v_add_f32_dpp v86, v86, v86 row_shr:1 row_mask:0xf bank_mask:0xf
    v_add_f32_dpp v87, v87, v87 row_shr:1 row_mask:0xf bank_mask:0xf
    v_add_f32_dpp v88, v88, v88 row_shr:1 row_mask:0xf bank_mask:0xf
    v_add_f32_dpp v89, v89, v89 row_shr:1 row_mask:0xf bank_mask:0xf
    v_add_f32_dpp v90, v90, v90 row_shr:1 row_mask:0xf bank_mask:0xf
    v_add_f32_dpp v91, v91, v91 row_shr:1 row_mask:0xf bank_mask:0xf
    v_add_f32_dpp v84, v84, v84 row_shr:2 row_mask:0xf bank_mask:0xf
    v_add_f32_dpp v85, v85, v85 row_shr:2 row_mask:0xf bank_mask:0xf
    v_add_f32_dpp v86, v86, v86 row_shr:2 row_mask:0xf bank_mask:0xf
    v_add_f32_dpp v87, v87, v87 row_shr:2 row_mask:0xf bank_mask:0xf
    v_add_f32_dpp v88, v88, v88 row_shr:2 row_mask:0xf bank_mask:0xf
    v_add_f32_dpp v89, v89, v89 row_shr:2 row_mask:0xf bank_mask:0xf
    v_add_f32_dpp v90, v90, v90 row_shr:2 row_mask:0xf bank_mask:0xf
    v_add_f32_dpp v91, v91, v91 row_shr:2 row_mask:0xf bank_mask:0xf
    v_add_f32_dpp v84, v84, v84 row_shr:4 row_mask:0xf bank_mask:0xf
    v_add_f32_dpp v85, v85, v85 row_shr:4 row_mask:0xf bank_mask:0xf
    v_add_f32_dpp v86, v86, v86 row_shr:4 row_mask:0xf bank_mask:0xf
    v_add_f32_dpp v87, v87, v87 row_shr:4 row_mask:0xf bank_mask:0xf
    v_add_f32_dpp v88, v88, v88 row_shr:4 row_mask:0xf bank_mask:0xf
    v_add_f32_dpp v89, v89, v89 row_shr:4 row_mask:0xf bank_mask:0xf
    v_add_f32_dpp v90, v90, v90 row_shr:4 row_mask:0xf bank_mask:0xf
    v_add_f32_dpp v91, v91, v91 row_shr:4 row_mask:0xf bank_mask:0xf
    v_add_f32_dpp v84, v84, v84 row_shr:8 row_mask:0xf bank_mask:0xf
    v_add_f32_dpp v85, v85, v85 row_shr:8 row_mask:0xf bank_mask:0xf
    v_add_f32_dpp v86, v86, v86 row_shr:8 row_mask:0xf bank_mask:0xf
    v_add_f32_dpp v87, v87, v87 row_shr:8 row_mask:0xf bank_mask:0xf
    v_add_f32_dpp v88, v88, v88 row_shr:8 row_mask:0xf bank_mask:0xf
    v_add_f32_dpp v89, v89, v89 row_shr:8 row_mask:0xf bank_mask:0xf
    v_add_f32_dpp v90, v90, v90 row_shr:8 row_mask:0xf bank_mask:0xf
    v_add_f32_dpp v91, v91, v91 row_shr:8 row_mask:0xf bank_mask:0xf
    v_add_f32_dpp v84, v84, v84 row_bcast:15 row_mask:0xa bank_mask:0xf
    v_add_f32_dpp v85, v85, v85 row_bcast:15 row_mask:0xa bank_mask:0xf
    v_add_f32_dpp v86, v86, v86 row_bcast:15 row_mask:0xa bank_mask:0xf
    v_add_f32_dpp v87, v87, v87 row_bcast:15 row_mask:0xa bank_mask:0xf
    v_add_f32_dpp v88, v88, v88 row_bcast:15 row_mask:0xa bank_mask:0xf
    v_add_f32_dpp v89, v89, v89 row_bcast:15 row_mask:0xa bank_mask:0xf
    v_add_f32_dpp v90, v90, v90 row_bcast:15 row_mask:0xa bank_mask:0xf
    v_add_f32_dpp v91, v91, v91 row_bcast:15 row_mask:0xa bank_mask:0xf
    v_add_f32_dpp v84, v84, v84 row_bcast:31 row_mask:0xc bank_mask:0xf
    v_add_f32_dpp v85, v85, v85 row_bcast:31 row_mask:0xc bank_mask:0xf
    v_add_f32_dpp v86, v86, v86 row_bcast:31 row_mask:0xc bank_mask:0xf
    v_add_f32_dpp v87, v87, v87 row_bcast:31 row_mask:0xc bank_mask:0xf
    v_add_f32_dpp v88, v88, v88 row_bcast:31 row_mask:0xc bank_mask:0xf
    v_add_f32_dpp v89, v89, v89 row_bcast:31 row_mask:0xc bank_mask:0xf
    v_add_f32_dpp v90, v90, v90 row_bcast:31 row_mask:0xc bank_mask:0xf
    v_add_f32_dpp v91, v91, v91 row_bcast:31 row_mask:0xc bank_mask:0xf
    v_cvt_pk_bf16_f32 v84, v84, v84
    v_cvt_pk_bf16_f32 v85, v85, v85
    v_cvt_pk_bf16_f32 v86, v86, v86
    v_cvt_pk_bf16_f32 v87, v87, v87
    v_cvt_pk_bf16_f32 v88, v88, v88
    v_cvt_pk_bf16_f32 v89, v89, v89
    v_cvt_pk_bf16_f32 v90, v90, v90
    v_cvt_pk_bf16_f32 v91, v91, v91
    v_lshlrev_b32 v84, 16, v84
    v_lshlrev_b32 v85, 16, v85
    v_lshlrev_b32 v86, 16, v86
    v_lshlrev_b32 v87, 16, v87
    v_lshlrev_b32 v88, 16, v88
    v_lshlrev_b32 v89, 16, v89
    v_lshlrev_b32 v90, 16, v90
    v_lshlrev_b32 v91, 16, v91
    v_mul_f32 v84, 0xbfb8aa3b, v84
    v_mul_f32 v85, 0xbfb8aa3b, v85
    v_mul_f32 v86, 0xbfb8aa3b, v86
    v_mul_f32 v87, 0xbfb8aa3b, v87
    v_mul_f32 v88, 0xbfb8aa3b, v88
    v_mul_f32 v89, 0xbfb8aa3b, v89
    v_mul_f32 v90, 0xbfb8aa3b, v90
    v_mul_f32 v91, 0xbfb8aa3b, v91
    v_exp_f32 v84, v84
    v_exp_f32 v85, v85
    v_exp_f32 v86, v86
    v_exp_f32 v87, v87
    v_exp_f32 v88, v88
    v_exp_f32 v89, v89
    v_exp_f32 v90, v90
    v_exp_f32 v91, v91
    v_add_f32 v84, 1.0, v84
    v_add_f32 v85, 1.0, v85
    v_add_f32 v86, 1.0, v86
    v_add_f32 v87, 1.0, v87
    v_add_f32 v88, 1.0, v88
    v_add_f32 v89, 1.0, v89
    v_add_f32 v90, 1.0, v90
    v_add_f32 v91, 1.0, v91
    v_rcp_f32 v84, v84
    v_rcp_f32 v85, v85
    v_rcp_f32 v86, v86
    v_rcp_f32 v87, v87
    v_rcp_f32 v88, v88
    v_rcp_f32 v89, v89
    v_rcp_f32 v90, v90
    v_rcp_f32 v91, v91
    v_cvt_pk_bf16_f32 v84, v84, v84
    v_cvt_pk_bf16_f32 v85, v85, v85
    v_cvt_pk_bf16_f32 v86, v86, v86
    v_cvt_pk_bf16_f32 v87, v87, v87
    v_cvt_pk_bf16_f32 v88, v88, v88
    v_cvt_pk_bf16_f32 v89, v89, v89
    v_cvt_pk_bf16_f32 v90, v90, v90
    v_cvt_pk_bf16_f32 v91, v91, v91
    v_lshlrev_b32 v84, 16, v84
    v_lshlrev_b32 v85, 16, v85
    v_lshlrev_b32 v86, 16, v86
    v_lshlrev_b32 v87, 16, v87
    v_lshlrev_b32 v88, 16, v88
    v_lshlrev_b32 v89, 16, v89
    v_lshlrev_b32 v90, 16, v90
    v_lshlrev_b32 v91, 16, v91
    s_lshl_b32 s52, s38, 2
    s_add_u32 s52, s52, 10813440
    v_mov_b32 v3, s52
    s_mov_b32 exec_lo, 0
    s_mov_b32 exec_hi, 0x80000000
    buffer_store_dwordx4 v[84:87], v3, s[40:43], 0 offen sc1
    buffer_store_dwordx4 v[88:91], v3, s[40:43], 0 offen offset:16 sc1
    s_mov_b64 exec, -1
    s_endpgm
L_k1_pf:
    s_load_dwordx2 s[64:65], s[0:1], 32
    s_mul_i32 s39, s2, 10240
    v_lshlrev_b32 v1, 4, v100
    v_add_u32 v1, s39, v1
    s_waitcnt lgkmcnt(0)
    s_mov_b32 s16, s64
    s_mov_b32 s17, s65
    s_mov_b32 s18, 2621440
    s_mov_b32 s19, 0x00020000
    s_barrier
    v_mov_b32 v6, 0
    s_mov_b32 s69, 0x40000
L_k1_pw:
    ds_read_b32 v7, v6
    s_waitcnt lgkmcnt(0)
    v_readfirstlane_b32 s63, v7
    s_sub_u32 s69, s69, 1
    s_cbranch_scc1 L_k1_pw_done
    s_cmp_ge_u32 s63, 4
    s_cbranch_scc1 L_k1_pw_done
    s_sleep 4
    s_branch L_k1_pw
L_k1_pw_done:
    s_movk_i32 s68, 0
    buffer_load_dwordx4 v[8:11], v1, s[16:19], s68 offen
    s_movk_i32 s68, 1024
    buffer_load_dwordx4 v[12:15], v1, s[16:19], s68 offen
    s_movk_i32 s68, 2048
    buffer_load_dwordx4 v[16:19], v1, s[16:19], s68 offen
    s_movk_i32 s68, 3072
    buffer_load_dwordx4 v[20:23], v1, s[16:19], s68 offen
    s_movk_i32 s68, 4096
    buffer_load_dwordx4 v[24:27], v1, s[16:19], s68 offen
    s_movk_i32 s68, 5120
    buffer_load_dwordx4 v[28:31], v1, s[16:19], s68 offen
    s_movk_i32 s68, 6144
    buffer_load_dwordx4 v[32:35], v1, s[16:19], s68 offen
    s_movk_i32 s68, 7168
    buffer_load_dwordx4 v[36:39], v1, s[16:19], s68 offen
    s_movk_i32 s68, 8192
    buffer_load_dwordx4 v[40:43], v1, s[16:19], s68 offen
    s_movk_i32 s68, 9216
    buffer_load_dwordx4 v[44:47], v1, s[16:19], s68 offen
    s_waitcnt vmcnt(0)
    s_endpgm
L_k1_end:
    s_endpgm
.globl k2_kernel
.p2align 8
.type k2_kernel,@function
k2_kernel:
    s_cmp_ge_u32 s2, 256
    s_cbranch_scc1 L_k2_end
    v_cmp_gt_u32 vcc, 64, v0
    s_cbranch_vccz L_cpf_4_skip
    s_getpc_b64 s[20:21]
L_cpf_4_pc:
    s_sub_u32 s20, s20, L_cpf_4_pc-k2_kernel
    s_subb_u32 s21, s21, 0
    v_lshlrev_b32 v2, 7, v0
    s_add_u32 s22, s20, k2_kernel-k2_kernel+0
    s_addc_u32 s23, s21, 0
    v_mov_b32 v5, s23
    v_add_co_u32 v4, vcc, s22, v2
    v_addc_co_u32 v5, vcc, 0, v5, vcc
    global_load_dword v159, v[4:5], off
    s_add_u32 s22, s20, k2_kernel-k2_kernel+8192
    s_addc_u32 s23, s21, 0
    v_mov_b32 v5, s23
    v_add_co_u32 v4, vcc, s22, v2
    v_addc_co_u32 v5, vcc, 0, v5, vcc
    v_cmp_gt_u32 vcc, 12, v0
    s_and_saveexec_b64 s[24:25], vcc
    global_load_dword v159, v[4:5], off
    s_mov_b64 exec, s[24:25]
L_cpf_4_skip:
    s_load_dwordx4 s[4:7], s[0:1], 32
    s_load_dwordx2 s[8:9], s[0:1], 112
    s_load_dwordx2 s[10:11], s[0:1], 128
    v_lshrrev_b32 v1, 6, v0
    v_and_b32 v150, 63, v0
    s_and_b32 s36, s2, 7
    v_readfirstlane_b32 s31, v1
    s_lshr_b32 s37, s2, 3
    s_lshr_b32 s38, s37, 2
    s_and_b32 s39, s37, 3
    s_mul_i32 s36, s36, 80
    s_mul_i32 s38, s38, 10
    s_add_u32 s36, s36, s38
    s_lshl_b32 s33, s39, 1
    s_add_u32 s33, s33, s36
    s_lshr_b32 s34, s39, 1
    s_add_u32 s34, s34, s36
    s_add_u32 s34, s34, 8
    s_and_b32 s35, s39, 1
    s_and_b32 s32, s31, 3
    v_lshlrev_b32 v153, 4, v150
    v_mov_b32 v155, 155968
    v_mov_b32 v156, 1
    s_cmp_eq_u32 s31, 11
    s_cbranch_scc0 L_k2_noflag
    v_mov_b32 v8, 0
    v_lshl_add_u32 v6, v150, 2, v155
    v_cmp_gt_u32 vcc, 16, v150
    s_and_saveexec_b64 s[42:43], vcc
    ds_write_b32 v6, v8
    s_mov_b64 exec, s[42:43]
L_k2_noflag:
    s_cmp_ge_u32 s31, 8
    s_cbranch_scc1 L_k2_helper
    s_setprio 2
    v_and_b32 v2, 15, v150
    v_lshrrev_b32 v3, 4, v150
    v_add_u32 v4, 1, v2
    v_and_b32 v5, 3, v4
    v_lshrrev_b32 v4, 2, v4
    v_mul_u32_u24 v5, 4160, v5
    v_lshl_add_u32 v5, v4, 3, v5
    v_lshl_add_u32 v151, v3, 4, v5
    v_lshlrev_b32 v4, 5, v2
    v_sub_u32 v4, 17120, v4
    v_lshl_add_u32 v152, v3, 4, v4
    s_mul_i32 s64, s32, 21216
    v_mov_b32 v161, 0
    s_cmp_eq_u32 s32, 0
    s_cbranch_scc0 L_k2_ta1
    v_lshrrev_b32 v2, 4, v150
    v_and_b32 v3, 15, v150
    v_lshl_add_u32 v4, v2, 5, v3
    v_lshlrev_b32 v160, 3, v4
    v_add_u32 v5, 1, v150
    v_lshrrev_b32 v2, 4, v5
    v_and_b32 v3, 15, v5
    v_lshl_add_u32 v4, v2, 5, v3
    v_lshlrev_b32 v162, 3, v4
    v_lshlrev_b32 v4, 3, v150
    v_add_u32 v4, 256, v4
    v_add_u32 v5, 8, v4
    v_cmp_le_u32 vcc, 32, v150
    v_mov_b32 v6, 512
    s_nop 0
    v_cndmask_b32 v160, v160, v4, vcc
    v_cndmask_b32 v162, v162, v5, vcc
    v_cmp_eq_u32 vcc, 31, v150
    v_add_u32 v161, 128, v160
    s_nop 0
    v_cndmask_b32 v162, v162, v6, vcc
    s_branch L_k2_tadone
L_k2_ta1:
    s_cmp_eq_u32 s32, 1
    s_cbranch_scc0 L_k2_ta3
    v_add_u32 v5, 1, v150
    v_lshrrev_b32 v2, 4, v150
    v_and_b32 v160, 15, v150
    v_lshrrev_b32 v3, 1, v2
    v_lshl_add_u32 v160, v3, 4, v160
    v_lshlrev_b32 v160, 3, v160
    v_and_b32 v2, 1, v2
    v_lshl_add_u32 v160, v2, 2, v160
    v_add_u32 v160, 768, v160
    v_lshrrev_b32 v2, 4, v5
    v_and_b32 v162, 15, v5
    v_lshrrev_b32 v3, 1, v2
    v_lshl_add_u32 v162, v3, 4, v162
    v_lshlrev_b32 v162, 3, v162
    v_and_b32 v2, 1, v2
    v_lshl_add_u32 v162, v2, 2, v162
    v_add_u32 v162, 768, v162
    v_cmp_eq_u32 vcc, 63, v150
    v_mov_b32 v6, 1024
    s_nop 0
    v_cndmask_b32 v162, v162, v6, vcc
    s_branch L_k2_tadone
L_k2_ta3:
    s_sub_u32 s48, s32, 2
    s_lshl_b32 s48, s48, 6
    v_add_u32 v4, s48, v150
    v_add_u32 v5, 1, v4
    v_lshrrev_b32 v2, 4, v4
    v_and_b32 v160, 15, v4
    v_lshrrev_b32 v3, 2, v2
    v_lshl_add_u32 v160, v3, 4, v160
    v_lshlrev_b32 v160, 3, v160
    v_and_b32 v2, 3, v2
    v_lshl_add_u32 v160, v2, 1, v160
    v_add_u32 v160, 1024, v160
    v_lshrrev_b32 v2, 4, v5
    v_and_b32 v162, 15, v5
    v_lshrrev_b32 v3, 2, v2
    v_lshl_add_u32 v162, v3, 4, v162
    v_lshlrev_b32 v162, 3, v162
    v_and_b32 v2, 3, v2
    v_lshl_add_u32 v162, v2, 1, v162
    v_add_u32 v162, 1024, v162
L_k2_tadone:
    s_waitcnt lgkmcnt(0)
    s_mov_b32 s12, s10
    s_mov_b32 s13, s11
    s_mov_b32 s14, 10821632
    s_mov_b32 s15, 0x00020000
    s_mov_b32 s96, 0x01000100
    s_mov_b32 s97, 0x03020302
    s_mov_b32 s98, 0x05040302
    s_mov_b32 s99, 0x05040100
    s_lshl_b32 s48, s32, 10
    s_add_u32 s48, s48, 32
    v_add_u32 v163, s48, v153
    v_lshrrev_b32 v2, 3, v150
    v_and_b32 v2, 3, v2
    v_mul_u32_u24 v2, 4160, v2
    v_and_b32 v3, 7, v150
    v_lshl_add_u32 v164, v3, 2, v2
    s_cmp_ge_u32 s31, 4
    s_cbranch_scc1 L_k2_Y
    s_mul_i32 s48, s34, 1536
    s_add_u32 s48, s48, 5406720
    s_cmp_eq_u32 s32, 0
    s_cbranch_scc0 L_tl_36_1
    buffer_load_dwordx2 v[40:41], v160, s[12:15], s48 offen
    buffer_load_dwordx2 v[42:43], v161, s[12:15], s48 offen
    buffer_load_dwordx2 v[44:45], v162, s[12:15], s48 offen
    s_branch L_tl_36_d
L_tl_36_1:
    s_cmp_eq_u32 s32, 1
    s_cbranch_scc0 L_tl_36_3
    buffer_load_dword v40, v160, s[12:15], s48 offen
    buffer_load_dword v42, v160, s[12:15], s48 offen
    buffer_load_dword v44, v162, s[12:15], s48 offen
    s_branch L_tl_36_d
L_tl_36_3:
    buffer_load_ushort v40, v160, s[12:15], s48 offen
    buffer_load_ushort v42, v160, s[12:15], s48 offen
    buffer_load_ushort v44, v162, s[12:15], s48 offen
L_tl_36_d:
    s_and_b32 s48, s32, 1
    s_mul_i32 s48, s48, 21216
    s_lshr_b32 s49, s32, 1
    s_lshl_b32 s49, s49, 8
    s_add_u32 s48, s48, s49
    s_add_u32 s67, s48, 84864
    s_mul_i32 s50, s32, 5120
    s_add_u32 s50, s50, 135488
    v_add_u32 v154, s50, v153
    s_barrier
    s_waitcnt vmcnt(0)
    s_mov_b32 s60, 84864
    s_getpc_b64 s[58:59]
L_call_37:
    s_add_u32 s58, s58, L_call_37_ret-L_call_37
    s_addc_u32 s59, s59, 0
    s_branch L_k2_expand
L_call_37_ret:
    s_waitcnt lgkmcnt(0)
    s_mov_b64 exec, 1
    ds_add_u32 v155, v156 offset:0
    s_mov_b64 exec, -1
    s_setprio 2
    s_mov_b32 s69, 0x40000
L_spin_38:
    ds_read_b32 v158, v155 offset:0
    s_waitcnt lgkmcnt(0)
    v_readfirstlane_b32 s68, v158
    s_sub_u32 s69, s69, 1
    s_cbranch_scc1 L_spin_38_done
    s_cmp_ge_u32 s68, 8
    s_cbranch_scc1 L_spin_38_done
    s_sleep 1
    s_branch L_spin_38
L_spin_38_done:
    s_cmp_eq_u32 s35, 0
    s_cbranch_scc0 L_k2_xO
    v_add_u32 v148, s67, v151
    v_add_u32 v149, s67, v152
    ds_read_b128 v[52:55], v149 offset:3584
    ds_read_b64 v[20:21], v148 offset:0
    ds_read_b64 v[22:23], v148 offset:8
    ds_read_b128 v[56:59], v149 offset:3072
    ds_read_b64 v[24:25], v148 offset:512
    ds_read_b64 v[26:27], v148 offset:520
    ds_read_b128 v[60:63], v149 offset:2560
    ds_read_b64 v[28:29], v148 offset:1024
    ds_read_b64 v[30:31], v148 offset:1032
    v_add_u32 v148, 64, v148
    v_add_u32 v149, 64, v149
    v_mov_b32 v0, 0
    v_mov_b32 v1, 0
    v_mov_b32 v2, 0
    v_mov_b32 v3, 0
    s_mov_b32 s66, 0
    s_waitcnt lgkmcnt(0)
L_phSE_39:
    v_mfma_f32_16x16x32_bf16 v[0:3], v[20:23], v[60:63], v[0:3]
    ds_read_b128 v[116:119], v149 offset:3584
    ds_read_b64 v[84:85], v148 offset:0
    ds_read_b64 v[86:87], v148 offset:8
    ds_read_b128 v[120:123], v149 offset:3072
    v_mfma_f32_16x16x32_bf16 v[0:3], v[24:27], v[56:59], v[0:3]
    ds_read_b64 v[88:89], v148 offset:512
    ds_read_b64 v[90:91], v148 offset:520
    ds_read_b128 v[124:127], v149 offset:2560
    ds_read_b64 v[92:93], v148 offset:1024
    v_mfma_f32_16x16x32_bf16 v[0:3], v[28:31], v[52:55], v[0:3]
    ds_read_b64 v[94:95], v148 offset:1032
    v_add_u32 v148, 64, v148
    v_add_u32 v149, 64, v149
    s_waitcnt lgkmcnt(0)
    v_mfma_f32_16x16x32_bf16 v[0:3], v[84:87], v[124:127], v[0:3]
    ds_read_b128 v[52:55], v149 offset:3584
    ds_read_b64 v[20:21], v148 offset:0
    ds_read_b64 v[22:23], v148 offset:8
    ds_read_b128 v[56:59], v149 offset:3072
    v_mfma_f32_16x16x32_bf16 v[0:3], v[88:91], v[120:123], v[0:3]
    ds_read_b64 v[24:25], v148 offset:512
    ds_read_b64 v[26:27], v148 offset:520
    ds_read_b128 v[60:63], v149 offset:2560
    ds_read_b64 v[28:29], v148 offset:1024
    v_mfma_f32_16x16x32_bf16 v[0:3], v[92:95], v[116:119], v[0:3]
    ds_read_b64 v[30:31], v148 offset:1032
    v_add_u32 v148, 64, v148
    v_add_u32 v149, 64, v149
    s_add_u32 s66, s66, 1
    s_cmp_lt_u32 s66, 2
    s_waitcnt lgkmcnt(0)
    s_cbranch_scc1 L_phSE_39
    s_nop 4
    ds_write_b128 v154, v[0:3] offset:0
    s_waitcnt lgkmcnt(0)
    s_mov_b64 exec, 1
    ds_add_u32 v155, v156 offset:4
    s_mov_b64 exec, -1
    v_add_u32 v148, s67, v151
    v_add_u32 v149, s67, v152
    ds_read_b128 v[52:55], v149 offset:3584
    ds_read_b64 v[20:21], v148 offset:0
    ds_read_b64 v[22:23], v148 offset:8
    ds_read_b128 v[56:59], v149 offset:3072
    ds_read_b64 v[24:25], v148 offset:512
    ds_read_b64 v[26:27], v148 offset:520
    ds_read_b128 v[60:63], v149 offset:2560
    ds_read_b64 v[28:29], v148 offset:1024
    ds_read_b64 v[30:31], v148 offset:1032
    ds_read_b128 v[64:67], v149 offset:2048
    ds_read_b64 v[32:33], v148 offset:1536
    ds_read_b64 v[34:35], v148 offset:1544
    ds_read_b128 v[68:71], v149 offset:1536
    ds_read_b64 v[36:37], v148 offset:2048
    ds_read_b64 v[38:39], v148 offset:2056
    ds_read_b128 v[72:75], v149 offset:1024
    ds_read_b64 v[40:41], v148 offset:2560
    ds_read_b64 v[42:43], v148 offset:2568
    ds_read_b128 v[76:79], v149 offset:512
    ds_read_b64 v[44:45], v148 offset:3072
    ds_read_b64 v[46:47], v148 offset:3080
    ds_read_b128 v[80:83], v149 offset:0
    ds_read_b64 v[48:49], v148 offset:3584
    ds_read_b64 v[50:51], v148 offset:3592
    v_add_u32 v148, 64, v148
    v_add_u32 v149, 64, v149
    v_mov_b32 v0, 0
    v_mov_b32 v1, 0
    v_mov_b32 v2, 0
    v_mov_b32 v3, 0
    v_mov_b32 v4, 0
    v_mov_b32 v5, 0
    v_mov_b32 v6, 0
    v_mov_b32 v7, 0
    s_mov_b32 s66, 0
    s_waitcnt lgkmcnt(0)
L_phSE_40:
    v_mfma_f32_16x16x32_bf16 v[0:3], v[20:23], v[80:83], v[0:3]
    ds_read_b128 v[116:119], v149 offset:3584
    ds_read_b64 v[84:85], v148 offset:0
    ds_read_b64 v[86:87], v148 offset:8
    v_mfma_f32_16x16x32_bf16 v[4:7], v[20:23], v[76:79], v[4:7]
    ds_read_b128 v[120:123], v149 offset:3072
    ds_read_b64 v[88:89], v148 offset:512
    v_mfma_f32_16x16x32_bf16 v[0:3], v[24:27], v[76:79], v[0:3]
    ds_read_b64 v[90:91], v148 offset:520
    ds_read_b128 v[124:127], v149 offset:2560
    v_mfma_f32_16x16x32_bf16 v[4:7], v[24:27], v[72:75], v[4:7]
    ds_read_b64 v[92:93], v148 offset:1024
    ds_read_b64 v[94:95], v148 offset:1032
    v_mfma_f32_16x16x32_bf16 v[0:3], v[28:31], v[72:75], v[0:3]
    ds_read_b128 v[128:131], v149 offset:2048
    ds_read_b64 v[96:97], v148 offset:1536
    v_mfma_f32_16x16x32_bf16 v[4:7], v[28:31], v[68:71], v[4:7]
    ds_read_b64 v[98:99], v148 offset:1544
    ds_read_b128 v[132:135], v149 offset:1536
    v_mfma_f32_16x16x32_bf16 v[0:3], v[32:35], v[68:71], v[0:3]
    ds_read_b64 v[100:101], v148 offset:2048
    ds_read_b64 v[102:103], v148 offset:2056
    v_mfma_f32_16x16x32_bf16 v[4:7], v[32:35], v[64:67], v[4:7]
    ds_read_b128 v[136:139], v149 offset:1024
    ds_read_b64 v[104:105], v148 offset:2560
    ds_read_b64 v[106:107], v148 offset:2568
    v_mfma_f32_16x16x32_bf16 v[0:3], v[36:39], v[64:67], v[0:3]
    ds_read_b128 v[140:143], v149 offset:512
    ds_read_b64 v[108:109], v148 offset:3072
    v_mfma_f32_16x16x32_bf16 v[4:7], v[36:39], v[60:63], v[4:7]
    ds_read_b64 v[110:111], v148 offset:3080
    ds_read_b128 v[144:147], v149 offset:0
    v_mfma_f32_16x16x32_bf16 v[0:3], v[40:43], v[60:63], v[0:3]
    ds_read_b64 v[112:113], v148 offset:3584
    ds_read_b64 v[114:115], v148 offset:3592
    v_mfma_f32_16x16x32_bf16 v[4:7], v[40:43], v[56:59], v[4:7]
    v_mfma_f32_16x16x32_bf16 v[0:3], v[44:47], v[56:59], v[0:3]
    v_mfma_f32_16x16x32_bf16 v[4:7], v[44:47], v[52:55], v[4:7]
    v_mfma_f32_16x16x32_bf16 v[0:3], v[48:51], v[52:55], v[0:3]
    v_add_u32 v148, 64, v148
    v_add_u32 v149, 64, v149
    s_waitcnt lgkmcnt(0)
    v_mfma_f32_16x16x32_bf16 v[0:3], v[84:87], v[144:147], v[0:3]
    ds_read_b128 v[52:55], v149 offset:3584
    ds_read_b64 v[20:21], v148 offset:0
    ds_read_b64 v[22:23], v148 offset:8
    v_mfma_f32_16x16x32_bf16 v[4:7], v[84:87], v[140:143], v[4:7]
    ds_read_b128 v[56:59], v149 offset:3072
    ds_read_b64 v[24:25], v148 offset:512
    v_mfma_f32_16x16x32_bf16 v[0:3], v[88:91], v[140:143], v[0:3]
    ds_read_b64 v[26:27], v148 offset:520
    ds_read_b128 v[60:63], v149 offset:2560
    v_mfma_f32_16x16x32_bf16 v[4:7], v[88:91], v[136:139], v[4:7]
    ds_read_b64 v[28:29], v148 offset:1024
    ds_read_b64 v[30:31], v148 offset:1032
    v_mfma_f32_16x16x32_bf16 v[0:3], v[92:95], v[136:139], v[0:3]
    ds_read_b128 v[64:67], v149 offset:2048
    ds_read_b64 v[32:33], v148 offset:1536
    v_mfma_f32_16x16x32_bf16 v[4:7], v[92:95], v[132:135], v[4:7]
    ds_read_b64 v[34:35], v148 offset:1544
    ds_read_b128 v[68:71], v149 offset:1536
    v_mfma_f32_16x16x32_bf16 v[0:3], v[96:99], v[132:135], v[0:3]
    ds_read_b64 v[36:37], v148 offset:2048
    ds_read_b64 v[38:39], v148 offset:2056
    v_mfma_f32_16x16x32_bf16 v[4:7], v[96:99], v[128:131], v[4:7]
    ds_read_b128 v[72:75], v149 offset:1024
    ds_read_b64 v[40:41], v148 offset:2560
    ds_read_b64 v[42:43], v148 offset:2568
    v_mfma_f32_16x16x32_bf16 v[0:3], v[100:103], v[128:131], v[0:3]
    ds_read_b128 v[76:79], v149 offset:512
    ds_read_b64 v[44:45], v148 offset:3072
    v_mfma_f32_16x16x32_bf16 v[4:7], v[100:103], v[124:127], v[4:7]
    ds_read_b64 v[46:47], v148 offset:3080
    ds_read_b128 v[80:83], v149 offset:0
    v_mfma_f32_16x16x32_bf16 v[0:3], v[104:107], v[124:127], v[0:3]
    ds_read_b64 v[48:49], v148 offset:3584
    ds_read_b64 v[50:51], v148 offset:3592
    v_mfma_f32_16x16x32_bf16 v[4:7], v[104:107], v[120:123], v[4:7]
    v_mfma_f32_16x16x32_bf16 v[0:3], v[108:111], v[120:123], v[0:3]
    v_mfma_f32_16x16x32_bf16 v[4:7], v[108:111], v[116:119], v[4:7]
    v_mfma_f32_16x16x32_bf16 v[0:3], v[112:115], v[116:119], v[0:3]
    v_add_u32 v148, 64, v148
    v_add_u32 v149, 64, v149
    s_add_u32 s66, s66, 1
    s_cmp_lt_u32 s66, 2
    s_waitcnt lgkmcnt(0)
    s_cbranch_scc1 L_phSE_40
    s_nop 4
    ds_write_b128 v154, v[0:3] offset:1024
    ds_write_b128 v154, v[4:7] offset:2048
    s_waitcnt lgkmcnt(0)
    s_mov_b64 exec, 1
    ds_add_u32 v155, v156 offset:8
    s_mov_b64 exec, -1
    s_branch L_k2_xSdone
L_k2_xO:
    v_add_u32 v148, s67, v151
    v_add_u32 v149, s67, v152
    ds_read_b128 v[52:55], v149 offset:3584
    ds_read_b64 v[20:21], v148 offset:0
    ds_read_b64 v[22:23], v148 offset:8
    ds_read_b128 v[56:59], v149 offset:3072
    ds_read_b64 v[24:25], v148 offset:512
    ds_read_b64 v[26:27], v148 offset:520
    v_add_u32 v148, 64, v148
    v_add_u32 v149, 64, v149
    v_mov_b32 v0, 0
    v_mov_b32 v1, 0
    v_mov_b32 v2, 0
    v_mov_b32 v3, 0
    v_mov_b32 v4, 0
    v_mov_b32 v5, 0
    v_mov_b32 v6, 0
    v_mov_b32 v7, 0
    s_mov_b32 s66, 0
    s_waitcnt lgkmcnt(0)
L_phSO_41:
    v_mfma_f32_16x16x32_bf16 v[0:3], v[20:23], v[56:59], v[0:3]
    ds_read_b128 v[116:119], v149 offset:3584
    ds_read_b64 v[84:85], v148 offset:0
    ds_read_b64 v[86:87], v148 offset:8
    v_mfma_f32_16x16x32_bf16 v[4:7], v[20:23], v[52:55], v[4:7]
    ds_read_b128 v[120:123], v149 offset:3072
    ds_read_b64 v[88:89], v148 offset:512
    ds_read_b64 v[90:91], v148 offset:520
    v_mfma_f32_16x16x32_bf16 v[0:3], v[24:27], v[52:55], v[0:3]
    v_add_u32 v148, 64, v148
    v_add_u32 v149, 64, v149
    s_waitcnt lgkmcnt(0)
    v_mfma_f32_16x16x32_bf16 v[0:3], v[84:87], v[120:123], v[0:3]
    ds_read_b128 v[52:55], v149 offset:3584
    ds_read_b64 v[20:21], v148 offset:0
    ds_read_b64 v[22:23], v148 offset:8
    v_mfma_f32_16x16x32_bf16 v[4:7], v[84:87], v[116:119], v[4:7]
    ds_read_b128 v[56:59], v149 offset:3072
    ds_read_b64 v[24:25], v148 offset:512
    ds_read_b64 v[26:27], v148 offset:520
    v_mfma_f32_16x16x32_bf16 v[0:3], v[88:91], v[116:119], v[0:3]
    v_add_u32 v148, 64, v148
    v_add_u32 v149, 64, v149
    s_add_u32 s66, s66, 1
    s_cmp_lt_u32 s66, 2
    s_waitcnt lgkmcnt(0)
    s_cbranch_scc1 L_phSO_41
    s_nop 4
    ds_write_b128 v154, v[0:3] offset:0
    ds_write_b128 v154, v[4:7] offset:1024
    s_waitcnt lgkmcnt(0)
    s_mov_b64 exec, 1
    ds_add_u32 v155, v156 offset:4
    s_mov_b64 exec, -1
    v_add_u32 v148, s67, v151
    v_add_u32 v149, s67, v152
    ds_read_b128 v[52:55], v149 offset:3584
    ds_read_b64 v[20:21], v148 offset:0
    ds_read_b64 v[22:23], v148 offset:8
    ds_read_b128 v[56:59], v149 offset:3072
    ds_read_b64 v[24:25], v148 offset:512
    ds_read_b64 v[26:27], v148 offset:520
    ds_read_b128 v[60:63], v149 offset:2560
    ds_read_b64 v[28:29], v148 offset:1024
    ds_read_b64 v[30:31], v148 offset:1032
    ds_read_b128 v[64:67], v149 offset:2048
    ds_read_b64 v[32:33], v148 offset:1536
    ds_read_b64 v[34:35], v148 offset:1544
    ds_read_b128 v[68:71], v149 offset:1536
    ds_read_b64 v[36:37], v148 offset:2048
    ds_read_b64 v[38:39], v148 offset:2056
    ds_read_b128 v[72:75], v149 offset:1024
    ds_read_b64 v[40:41], v148 offset:2560
    ds_read_b64 v[42:43], v148 offset:2568
    v_add_u32 v148, 64, v148
    v_add_u32 v149, 64, v149
    v_mov_b32 v0, 0
    v_mov_b32 v1, 0
    v_mov_b32 v2, 0
    v_mov_b32 v3, 0
    v_mov_b32 v4, 0
    v_mov_b32 v5, 0
    v_mov_b32 v6, 0
    v_mov_b32 v7, 0
    v_mov_b32 v8, 0
    v_mov_b32 v9, 0
    v_mov_b32 v10, 0
    v_mov_b32 v11, 0
    s_mov_b32 s66, 0
    s_waitcnt lgkmcnt(0)
L_phSO_42:
    v_mfma_f32_16x16x32_bf16 v[0:3], v[20:23], v[72:75], v[0:3]
    ds_read_b128 v[116:119], v149 offset:3584
    ds_read_b64 v[84:85], v148 offset:0
    v_mfma_f32_16x16x32_bf16 v[4:7], v[20:23], v[68:71], v[4:7]
    ds_read_b64 v[86:87], v148 offset:8
    ds_read_b128 v[120:123], v149 offset:3072
    v_mfma_f32_16x16x32_bf16 v[8:11], v[20:23], v[64:67], v[8:11]
    ds_read_b64 v[88:89], v148 offset:512
    v_mfma_f32_16x16x32_bf16 v[0:3], v[24:27], v[68:71], v[0:3]
    ds_read_b64 v[90:91], v148 offset:520
    ds_read_b128 v[124:127], v149 offset:2560
    v_mfma_f32_16x16x32_bf16 v[4:7], v[24:27], v[64:67], v[4:7]
    ds_read_b64 v[92:93], v148 offset:1024
    v_mfma_f32_16x16x32_bf16 v[8:11], v[24:27], v[60:63], v[8:11]
    ds_read_b64 v[94:95], v148 offset:1032
    ds_read_b128 v[128:131], v149 offset:2048
    v_mfma_f32_16x16x32_bf16 v[0:3], v[28:31], v[64:67], v[0:3]
    ds_read_b64 v[96:97], v148 offset:1536
    ds_read_b64 v[98:99], v148 offset:1544
    v_mfma_f32_16x16x32_bf16 v[4:7], v[28:31], v[60:63], v[4:7]
    ds_read_b128 v[132:135], v149 offset:1536
    v_mfma_f32_16x16x32_bf16 v[8:11], v[28:31], v[56:59], v[8:11]
    ds_read_b64 v[100:101], v148 offset:2048
    ds_read_b64 v[102:103], v148 offset:2056
    v_mfma_f32_16x16x32_bf16 v[0:3], v[32:35], v[60:63], v[0:3]
    ds_read_b128 v[136:139], v149 offset:1024
    v_mfma_f32_16x16x32_bf16 v[4:7], v[32:35], v[56:59], v[4:7]
    ds_read_b64 v[104:105], v148 offset:2560
    ds_read_b64 v[106:107], v148 offset:2568
    v_mfma_f32_16x16x32_bf16 v[8:11], v[32:35], v[52:55], v[8:11]
    v_mfma_f32_16x16x32_bf16 v[0:3], v[36:39], v[56:59], v[0:3]
    v_mfma_f32_16x16x32_bf16 v[4:7], v[36:39], v[52:55], v[4:7]
    v_mfma_f32_16x16x32_bf16 v[0:3], v[40:43], v[52:55], v[0:3]
    v_add_u32 v148, 64, v148
    v_add_u32 v149, 64, v149
    s_waitcnt lgkmcnt(0)
    v_mfma_f32_16x16x32_bf16 v[0:3], v[84:87], v[136:139], v[0:3]
    ds_read_b128 v[52:55], v149 offset:3584
    ds_read_b64 v[20:21], v148 offset:0
    v_mfma_f32_16x16x32_bf16 v[4:7], v[84:87], v[132:135], v[4:7]
    ds_read_b64 v[22:23], v148 offset:8
    ds_read_b128 v[56:59], v149 offset:3072
    v_mfma_f32_16x16x32_bf16 v[8:11], v[84:87], v[128:131], v[8:11]
    ds_read_b64 v[24:25], v148 offset:512
    v_mfma_f32_16x16x32_bf16 v[0:3], v[88:91], v[132:135], v[0:3]
    ds_read_b64 v[26:27], v148 offset:520
    ds_read_b128 v[60:63], v149 offset:2560
    v_mfma_f32_16x16x32_bf16 v[4:7], v[88:91], v[128:131], v[4:7]
    ds_read_b64 v[28:29], v148 offset:1024
    v_mfma_f32_16x16x32_bf16 v[8:11], v[88:91], v[124:127], v[8:11]
    ds_read_b64 v[30:31], v148 offset:1032
    ds_read_b128 v[64:67], v149 offset:2048
    v_mfma_f32_16x16x32_bf16 v[0:3], v[92:95], v[128:131], v[0:3]
    ds_read_b64 v[32:33], v148 offset:1536
    ds_read_b64 v[34:35], v148 offset:1544
    v_mfma_f32_16x16x32_bf16 v[4:7], v[92:95], v[124:127], v[4:7]
    ds_read_b128 v[68:71], v149 offset:1536
    v_mfma_f32_16x16x32_bf16 v[8:11], v[92:95], v[120:123], v[8:11]
    ds_read_b64 v[36:37], v148 offset:2048
    ds_read_b64 v[38:39], v148 offset:2056
    v_mfma_f32_16x16x32_bf16 v[0:3], v[96:99], v[124:127], v[0:3]
    ds_read_b128 v[72:75], v149 offset:1024
    v_mfma_f32_16x16x32_bf16 v[4:7], v[96:99], v[120:123], v[4:7]
    ds_read_b64 v[40:41], v148 offset:2560
    ds_read_b64 v[42:43], v148 offset:2568
    v_mfma_f32_16x16x32_bf16 v[8:11], v[96:99], v[116:119], v[8:11]
    v_mfma_f32_16x16x32_bf16 v[0:3], v[100:103], v[120:123], v[0:3]
    v_mfma_f32_16x16x32_bf16 v[4:7], v[100:103], v[116:119], v[4:7]
    v_mfma_f32_16x16x32_bf16 v[0:3], v[104:107], v[116:119], v[0:3]
    v_add_u32 v148, 64, v148
    v_add_u32 v149, 64, v149
    s_add_u32 s66, s66, 1
    s_cmp_lt_u32 s66, 2
    s_waitcnt lgkmcnt(0)
    s_cbranch_scc1 L_phSO_42
    s_nop 4
    ds_write_b128 v154, v[0:3] offset:2048
    ds_write_b128 v154, v[4:7] offset:3072
    ds_write_b128 v154, v[8:11] offset:4096
    s_waitcnt lgkmcnt(0)
    s_mov_b64 exec, 1
    ds_add_u32 v155, v156 offset:8
    s_mov_b64 exec, -1
L_k2_xSdone:
    s_setprio 1
    s_mov_b32 s69, 0x40000
L_spin_43:
    ds_read_b32 v158, v155 offset:28
    s_waitcnt lgkmcnt(0)
    v_readfirstlane_b32 s68, v158
    s_sub_u32 s69, s69, 1
    s_cbranch_scc1 L_spin_43_done
    s_cmp_ge_u32 s68, 4
    s_cbranch_scc1 L_spin_43_done
    s_sleep 1
    s_branch L_spin_43
L_spin_43_done:
    v_add_u32 v148, s64, v151
    v_add_u32 v149, s64, v152
    ds_read_b128 v[52:55], v149 offset:3584
    ds_read_b64 v[20:21], v148 offset:0
    ds_read_b64 v[22:23], v148 offset:8
    ds_read_b128 v[56:59], v149 offset:3072
    ds_read_b64 v[24:25], v148 offset:512
    ds_read_b64 v[26:27], v148 offset:520
    ds_read_b128 v[60:63], v149 offset:2560
    ds_read_b64 v[28:29], v148 offset:1024
    ds_read_b64 v[30:31], v148 offset:1032
    ds_read_b128 v[64:67], v149 offset:2048
    ds_read_b64 v[32:33], v148 offset:1536
    ds_read_b64 v[34:35], v148 offset:1544
    ds_read_b128 v[68:71], v149 offset:1536
    ds_read_b64 v[36:37], v148 offset:2048
    ds_read_b64 v[38:39], v148 offset:2056
    ds_read_b128 v[72:75], v149 offset:1024
    ds_read_b64 v[40:41], v148 offset:2560
    ds_read_b64 v[42:43], v148 offset:2568
    v_add_u32 v148, 64, v148
    v_add_u32 v149, 64, v149
    v_mov_b32 v0, 0
    v_mov_b32 v1, 0
    v_mov_b32 v2, 0
    v_mov_b32 v3, 0
    v_mov_b32 v4, 0
    v_mov_b32 v5, 0
    v_mov_b32 v6, 0
    v_mov_b32 v7, 0
    s_mov_b32 s66, 0
    s_waitcnt lgkmcnt(0)
L_phH1_44:
    v_mfma_f32_16x16x32_bf16 v[0:3], v[20:23], v[68:71], v[0:3]
    ds_read_b128 v[116:119], v149 offset:3584
    ds_read_b64 v[84:85], v148 offset:0
    ds_read_b64 v[86:87], v148 offset:8
    v_mfma_f32_16x16x32_bf16 v[4:7], v[20:23], v[72:75], v[4:7]
    ds_read_b128 v[120:123], v149 offset:3072
    ds_read_b64 v[88:89], v148 offset:512
    v_mfma_f32_16x16x32_bf16 v[0:3], v[24:27], v[64:67], v[0:3]
    ds_read_b64 v[90:91], v148 offset:520
    ds_read_b128 v[124:127], v149 offset:2560
    v_mfma_f32_16x16x32_bf16 v[4:7], v[24:27], v[68:71], v[4:7]
    ds_read_b64 v[92:93], v148 offset:1024
    ds_read_b64 v[94:95], v148 offset:1032
    v_mfma_f32_16x16x32_bf16 v[0:3], v[28:31], v[60:63], v[0:3]
    ds_read_b128 v[128:131], v149 offset:2048
    ds_read_b64 v[96:97], v148 offset:1536
    v_mfma_f32_16x16x32_bf16 v[4:7], v[28:31], v[64:67], v[4:7]
    ds_read_b64 v[98:99], v148 offset:1544
    ds_read_b128 v[132:135], v149 offset:1536
    ds_read_b64 v[100:101], v148 offset:2048
    v_mfma_f32_16x16x32_bf16 v[0:3], v[32:35], v[56:59], v[0:3]
    ds_read_b64 v[102:103], v148 offset:2056
    ds_read_b128 v[136:139], v149 offset:1024
    v_mfma_f32_16x16x32_bf16 v[4:7], v[32:35], v[60:63], v[4:7]
    ds_read_b64 v[104:105], v148 offset:2560
    ds_read_b64 v[106:107], v148 offset:2568
    v_mfma_f32_16x16x32_bf16 v[0:3], v[36:39], v[52:55], v[0:3]
    v_mfma_f32_16x16x32_bf16 v[4:7], v[36:39], v[56:59], v[4:7]
    v_mfma_f32_16x16x32_bf16 v[4:7], v[40:43], v[52:55], v[4:7]
    v_add_u32 v148, 64, v148
    v_add_u32 v149, 64, v149
    s_waitcnt lgkmcnt(0)
    v_mfma_f32_16x16x32_bf16 v[0:3], v[84:87], v[132:135], v[0:3]
    ds_read_b128 v[52:55], v149 offset:3584
    ds_read_b64 v[20:21], v148 offset:0
    ds_read_b64 v[22:23], v148 offset:8
    v_mfma_f32_16x16x32_bf16 v[4:7], v[84:87], v[136:139], v[4:7]
    ds_read_b128 v[56:59], v149 offset:3072
    ds_read_b64 v[24:25], v148 offset:512
    v_mfma_f32_16x16x32_bf16 v[0:3], v[88:91], v[128:131], v[0:3]
    ds_read_b64 v[26:27], v148 offset:520
    ds_read_b128 v[60:63], v149 offset:2560
    v_mfma_f32_16x16x32_bf16 v[4:7], v[88:91], v[132:135], v[4:7]
    ds_read_b64 v[28:29], v148 offset:1024
    ds_read_b64 v[30:31], v148 offset:1032
    v_mfma_f32_16x16x32_bf16 v[0:3], v[92:95], v[124:127], v[0:3]
    ds_read_b128 v[64:67], v149 offset:2048
    ds_read_b64 v[32:33], v148 offset:1536
    v_mfma_f32_16x16x32_bf16 v[4:7], v[92:95], v[128:131], v[4:7]
    ds_read_b64 v[34:35], v148 offset:1544
    ds_read_b128 v[68:71], v149 offset:1536
    ds_read_b64 v[36:37], v148 offset:2048
    v_mfma_f32_16x16x32_bf16 v[0:3], v[96:99], v[120:123], v[0:3]
    ds_read_b64 v[38:39], v148 offset:2056
    ds_read_b128 v[72:75], v149 offset:1024
    v_mfma_f32_16x16x32_bf16 v[4:7], v[96:99], v[124:127], v[4:7]
    ds_read_b64 v[40:41], v148 offset:2560
    ds_read_b64 v[42:43], v148 offset:2568
    v_mfma_f32_16x16x32_bf16 v[0:3], v[100:103], v[116:119], v[0:3]
    v_mfma_f32_16x16x32_bf16 v[4:7], v[100:103], v[120:123], v[4:7]
    v_mfma_f32_16x16x32_bf16 v[4:7], v[104:107], v[116:119], v[4:7]
    v_add_u32 v148, 64, v148
    v_add_u32 v149, 64, v149
    s_add_u32 s66, s66, 1
    s_cmp_lt_u32 s66, 4
    s_waitcnt lgkmcnt(0)
    s_cbranch_scc1 L_phH1_44
    s_nop 4
    s_mov_b32 s69, 0x40000
L_spin_45:
    ds_read_b32 v158, v155 offset:8
    s_waitcnt lgkmcnt(0)
    v_readfirstlane_b32 s68, v158
    s_sub_u32 s69, s69, 1
    s_cbranch_scc1 L_spin_45_done
    s_cmp_ge_u32 s68, 4
    s_cbranch_scc1 L_spin_45_done
    s_sleep 1
    s_branch L_spin_45
L_spin_45_done:
    s_lshl_b32 s48, s32, 12
    s_add_u32 s48, s48, 106080
    v_add_u32 v154, s48, v153
    ds_write_b128 v154, v[0:3] offset:0
    ds_write_b128 v154, v[4:7] offset:1024
    s_waitcnt lgkmcnt(0)
    s_mov_b64 exec, 1
    ds_add_u32 v155, v156 offset:16
    s_mov_b64 exec, -1
    s_endpgm
L_k2_Y:
    s_add_u32 s52, s33, 1
    s_mul_i32 s48, s33, 1536
    s_add_u32 s48, s48, 5406720
    s_cmp_eq_u32 s32, 0
    s_cbranch_scc0 L_tl_46_1
    buffer_load_dwordx2 v[40:41], v160, s[12:15], s48 offen
    buffer_load_dwordx2 v[42:43], v161, s[12:15], s48 offen
    buffer_load_dwordx2 v[44:45], v162, s[12:15], s48 offen
    s_branch L_tl_46_d
L_tl_46_1:
    s_cmp_eq_u32 s32, 1
    s_cbranch_scc0 L_tl_46_3
    buffer_load_dword v40, v160, s[12:15], s48 offen
    buffer_load_dword v42, v160, s[12:15], s48 offen
    buffer_load_dword v44, v162, s[12:15], s48 offen
    s_branch L_tl_46_d
L_tl_46_3:
    buffer_load_ushort v40, v160, s[12:15], s48 offen
    buffer_load_ushort v42, v160, s[12:15], s48 offen
    buffer_load_ushort v44, v162, s[12:15], s48 offen
L_tl_46_d:
    s_mul_i32 s48, s52, 1536
    s_add_u32 s48, s48, 5406720
    s_cmp_eq_u32 s32, 0
    s_cbranch_scc0 L_tl_47_1
    buffer_load_dwordx2 v[56:57], v160, s[12:15], s48 offen
    buffer_load_dwordx2 v[58:59], v161, s[12:15], s48 offen
    buffer_load_dwordx2 v[60:61], v162, s[12:15], s48 offen
    s_branch L_tl_47_d
L_tl_47_1:
    s_cmp_eq_u32 s32, 1
    s_cbranch_scc0 L_tl_47_3
    buffer_load_dword v56, v160, s[12:15], s48 offen
    buffer_load_dword v58, v160, s[12:15], s48 offen
    buffer_load_dword v60, v162, s[12:15], s48 offen
    s_branch L_tl_47_d
L_tl_47_3:
    buffer_load_ushort v56, v160, s[12:15], s48 offen
    buffer_load_ushort v58, v160, s[12:15], s48 offen
    buffer_load_ushort v60, v162, s[12:15], s48 offen
L_tl_47_d:
    s_barrier
    s_waitcnt vmcnt(3)
    s_mov_b32 s60, 0
    s_getpc_b64 s[58:59]
L_call_48:
    s_add_u32 s58, s58, L_call_48_ret-L_call_48
    s_addc_u32 s59, s59, 0
    s_branch L_k2_expand
L_call_48_ret:
    s_waitcnt vmcnt(0)
    s_mov_b32 s60, 42432
    v_mov_b32 v40, v56
    v_mov_b32 v41, v57
    v_mov_b32 v42, v58
    v_mov_b32 v43, v59
    v_mov_b32 v44, v60
    v_mov_b32 v45, v61
    s_getpc_b64 s[58:59]
L_call_49:
    s_add_u32 s58, s58, L_call_49_ret-L_call_49
    s_addc_u32 s59, s59, 0
    s_branch L_k2_expand
L_call_49_ret:
    s_waitcnt lgkmcnt(0)
    s_mov_b64 exec, 1
    ds_add_u32 v155, v156 offset:24
    s_mov_b64 exec, -1
    s_setprio 2
    s_mov_b32 s69, 0x40000
L_spin_50:
    ds_read_b32 v158, v155 offset:24
    s_waitcnt lgkmcnt(0)
    v_readfirstlane_b32 s68, v158
    s_sub_u32 s69, s69, 1
    s_cbranch_scc1 L_spin_50_done
    s_cmp_ge_u32 s68, 8
    s_cbranch_scc1 L_spin_50_done
    s_sleep 1
    s_branch L_spin_50
L_spin_50_done:
    v_add_u32 v148, s64, v151
    v_add_u32 v149, s64, v152
    ds_read_b128 v[52:55], v149 offset:3584
    ds_read_b64 v[20:21], v148 offset:0
    ds_read_b64 v[22:23], v148 offset:8
    ds_read_b128 v[56:59], v149 offset:3072
    ds_read_b64 v[24:25], v148 offset:512
    ds_read_b64 v[26:27], v148 offset:520
    ds_read_b128 v[60:63], v149 offset:2560
    ds_read_b64 v[28:29], v148 offset:1024
    ds_read_b64 v[30:31], v148 offset:1032
    ds_read_b128 v[64:67], v149 offset:2048
    ds_read_b64 v[32:33], v148 offset:1536
    ds_read_b64 v[34:35], v148 offset:1544
    v_add_u32 v148, 64, v148
    v_add_u32 v149, 64, v149
    v_mov_b32 v0, 0
    v_mov_b32 v1, 0
    v_mov_b32 v2, 0
    v_mov_b32 v3, 0
    v_mov_b32 v4, 0
    v_mov_b32 v5, 0
    v_mov_b32 v6, 0
    v_mov_b32 v7, 0
    v_mov_b32 v8, 0
    v_mov_b32 v9, 0
    v_mov_b32 v10, 0
    v_mov_b32 v11, 0
    v_mov_b32 v12, 0
    v_mov_b32 v13, 0
    v_mov_b32 v14, 0
    v_mov_b32 v15, 0
    s_mov_b32 s66, 0
    s_waitcnt lgkmcnt(0)
L_phL_51:
    v_mfma_f32_16x16x32_bf16 v[0:3], v[20:23], v[52:55], v[0:3]
    ds_read_b128 v[116:119], v149 offset:3584
    ds_read_b64 v[84:85], v148 offset:0
    v_mfma_f32_16x16x32_bf16 v[4:7], v[20:23], v[56:59], v[4:7]
    ds_read_b64 v[86:87], v148 offset:8
    ds_read_b128 v[120:123], v149 offset:3072
    v_mfma_f32_16x16x32_bf16 v[8:11], v[20:23], v[60:63], v[8:11]
    ds_read_b64 v[88:89], v148 offset:512
    v_mfma_f32_16x16x32_bf16 v[12:15], v[20:23], v[64:67], v[12:15]
    ds_read_b64 v[90:91], v148 offset:520
    ds_read_b128 v[124:127], v149 offset:2560
    v_mfma_f32_16x16x32_bf16 v[4:7], v[24:27], v[52:55], v[4:7]
    ds_read_b64 v[92:93], v148 offset:1024
    v_mfma_f32_16x16x32_bf16 v[8:11], v[24:27], v[56:59], v[8:11]
    ds_read_b64 v[94:95], v148 offset:1032
    ds_read_b128 v[128:131], v149 offset:2048
    v_mfma_f32_16x16x32_bf16 v[12:15], v[24:27], v[60:63], v[12:15]
    ds_read_b64 v[96:97], v148 offset:1536
    ds_read_b64 v[98:99], v148 offset:1544
    v_mfma_f32_16x16x32_bf16 v[8:11], v[28:31], v[52:55], v[8:11]
    v_mfma_f32_16x16x32_bf16 v[12:15], v[28:31], v[56:59], v[12:15]
    v_mfma_f32_16x16x32_bf16 v[12:15], v[32:35], v[52:55], v[12:15]
    v_add_u32 v148, 64, v148
    v_add_u32 v149, 64, v149
    s_waitcnt lgkmcnt(0)
    v_mfma_f32_16x16x32_bf16 v[0:3], v[84:87], v[116:119], v[0:3]
    ds_read_b128 v[52:55], v149 offset:3584
    ds_read_b64 v[20:21], v148 offset:0
    v_mfma_f32_16x16x32_bf16 v[4:7], v[84:87], v[120:123], v[4:7]
    ds_read_b64 v[22:23], v148 offset:8
    ds_read_b128 v[56:59], v149 offset:3072
    v_mfma_f32_16x16x32_bf16 v[8:11], v[84:87], v[124:127], v[8:11]
    ds_read_b64 v[24:25], v148 offset:512
    v_mfma_f32_16x16x32_bf16 v[12:15], v[84:87], v[128:131], v[12:15]
    ds_read_b64 v[26:27], v148 offset:520
    ds_read_b128 v[60:63], v149 offset:2560
    v_mfma_f32_16x16x32_bf16 v[4:7], v[88:91], v[116:119], v[4:7]
    ds_read_b64 v[28:29], v148 offset:1024
    v_mfma_f32_16x16x32_bf16 v[8:11], v[88:91], v[120:123], v[8:11]
    ds_read_b64 v[30:31], v148 offset:1032
    ds_read_b128 v[64:67], v149 offset:2048
    v_mfma_f32_16x16x32_bf16 v[12:15], v[88:91], v[124:127], v[12:15]
    ds_read_b64 v[32:33], v148 offset:1536
    ds_read_b64 v[34:35], v148 offset:1544
    v_mfma_f32_16x16x32_bf16 v[8:11], v[92:95], v[116:119], v[8:11]
    v_mfma_f32_16x16x32_bf16 v[12:15], v[92:95], v[120:123], v[12:15]
    v_mfma_f32_16x16x32_bf16 v[12:15], v[96:99], v[116:119], v[12:15]
    v_add_u32 v148, 64, v148
    v_add_u32 v149, 64, v149
    s_add_u32 s66, s66, 1
    s_cmp_lt_u32 s66, 4
    s_waitcnt lgkmcnt(0)
    s_cbranch_scc1 L_phL_51
    s_nop 4
    s_mov_b32 s69, 0x40000
L_spin_52:
    ds_read_b32 v158, v155 offset:8
    s_waitcnt lgkmcnt(0)
    v_readfirstlane_b32 s68, v158
    s_sub_u32 s69, s69, 1
    s_cbranch_scc1 L_spin_52_done
    s_cmp_ge_u32 s68, 4
    s_cbranch_scc1 L_spin_52_done
    s_sleep 1
    s_branch L_spin_52
L_spin_52_done:
    s_lshl_b32 s48, s32, 12
    s_add_u32 s48, s48, 84864
    v_add_u32 v154, s48, v153
    ds_write_b128 v154, v[0:3] offset:0
    ds_write_b128 v154, v[4:7] offset:1024
    ds_write_b128 v154, v[8:11] offset:2048
    ds_write_b128 v154, v[12:15] offset:3072
    s_waitcnt lgkmcnt(0)
    s_mov_b64 exec, 1
    ds_add_u32 v155, v156 offset:12
    s_mov_b64 exec, -1
    s_setprio 0
    s_mov_b32 s69, 0x40000
L_spin_53:
    ds_read_b32 v158, v155 offset:28
    s_waitcnt lgkmcnt(0)
    v_readfirstlane_b32 s68, v158
    s_sub_u32 s69, s69, 1
    s_cbranch_scc1 L_spin_53_done
    s_cmp_ge_u32 s68, 4
    s_cbranch_scc1 L_spin_53_done
    s_sleep 1
    s_branch L_spin_53
L_spin_53_done:
    v_add_u32 v148, s64, v151
    v_add_u32 v149, s64, v152
    ds_read_b128 v[52:55], v149 offset:3584
    ds_read_b64 v[20:21], v148 offset:0
    ds_read_b64 v[22:23], v148 offset:8
    ds_read_b128 v[56:59], v149 offset:3072
    ds_read_b64 v[24:25], v148 offset:512
    ds_read_b64 v[26:27], v148 offset:520
    ds_read_b128 v[60:63], v149 offset:2560
    ds_read_b64 v[28:29], v148 offset:1024
    ds_read_b64 v[30:31], v148 offset:1032
    ds_read_b128 v[64:67], v149 offset:2048
    ds_read_b64 v[32:33], v148 offset:1536
    ds_read_b64 v[34:35], v148 offset:1544
    ds_read_b128 v[68:71], v149 offset:1536
    ds_read_b64 v[36:37], v148 offset:2048
    ds_read_b64 v[38:39], v148 offset:2056
    ds_read_b128 v[72:75], v149 offset:1024
    ds_read_b64 v[40:41], v148 offset:2560
    ds_read_b64 v[42:43], v148 offset:2568
    ds_read_b128 v[76:79], v149 offset:512
    ds_read_b64 v[44:45], v148 offset:3072
    ds_read_b64 v[46:47], v148 offset:3080
    ds_read_b128 v[80:83], v149 offset:0
    ds_read_b64 v[48:49], v148 offset:3584
    ds_read_b64 v[50:51], v148 offset:3592
    v_add_u32 v148, 64, v148
    v_add_u32 v149, 64, v149
    v_mov_b32 v0, 0
    v_mov_b32 v1, 0
    v_mov_b32 v2, 0
    v_mov_b32 v3, 0
    v_mov_b32 v4, 0
    v_mov_b32 v5, 0
    v_mov_b32 v6, 0
    v_mov_b32 v7, 0
    s_mov_b32 s66, 0
    s_waitcnt lgkmcnt(0)
L_phH2_54:
    s_cmp_eq_u32 s66, 1
    s_cbranch_scc0 L_phH2_54_sw
    s_setprio 2
L_phH2_54_sw:
    v_mfma_f32_16x16x32_bf16 v[0:3], v[20:23], v[76:79], v[0:3]
    ds_read_b128 v[116:119], v149 offset:3584
    ds_read_b64 v[84:85], v148 offset:0
    ds_read_b64 v[86:87], v148 offset:8
    v_mfma_f32_16x16x32_bf16 v[4:7], v[20:23], v[80:83], v[4:7]
    ds_read_b128 v[120:123], v149 offset:3072
    ds_read_b64 v[88:89], v148 offset:512
    v_mfma_f32_16x16x32_bf16 v[0:3], v[24:27], v[72:75], v[0:3]
    ds_read_b64 v[90:91], v148 offset:520
    ds_read_b128 v[124:127], v149 offset:2560
    v_mfma_f32_16x16x32_bf16 v[4:7], v[24:27], v[76:79], v[4:7]
    ds_read_b64 v[92:93], v148 offset:1024
    ds_read_b64 v[94:95], v148 offset:1032
    v_mfma_f32_16x16x32_bf16 v[0:3], v[28:31], v[68:71], v[0:3]
    ds_read_b128 v[128:131], v149 offset:2048
    ds_read_b64 v[96:97], v148 offset:1536
    v_mfma_f32_16x16x32_bf16 v[4:7], v[28:31], v[72:75], v[4:7]
    ds_read_b64 v[98:99], v148 offset:1544
    ds_read_b128 v[132:135], v149 offset:1536
    v_mfma_f32_16x16x32_bf16 v[0:3], v[32:35], v[64:67], v[0:3]
    ds_read_b64 v[100:101], v148 offset:2048
    ds_read_b64 v[102:103], v148 offset:2056
    v_mfma_f32_16x16x32_bf16 v[4:7], v[32:35], v[68:71], v[4:7]
    ds_read_b128 v[136:139], v149 offset:1024
    ds_read_b64 v[104:105], v148 offset:2560
    ds_read_b64 v[106:107], v148 offset:2568
    v_mfma_f32_16x16x32_bf16 v[0:3], v[36:39], v[60:63], v[0:3]
    ds_read_b128 v[140:143], v149 offset:512
    ds_read_b64 v[108:109], v148 offset:3072
    v_mfma_f32_16x16x32_bf16 v[4:7], v[36:39], v[64:67], v[4:7]
    ds_read_b64 v[110:111], v148 offset:3080
    ds_read_b128 v[144:147], v149 offset:0
    v_mfma_f32_16x16x32_bf16 v[0:3], v[40:43], v[56:59], v[0:3]
    ds_read_b64 v[112:113], v148 offset:3584
    ds_read_b64 v[114:115], v148 offset:3592
    v_mfma_f32_16x16x32_bf16 v[4:7], v[40:43], v[60:63], v[4:7]
    v_mfma_f32_16x16x32_bf16 v[0:3], v[44:47], v[52:55], v[0:3]
    v_mfma_f32_16x16x32_bf16 v[4:7], v[44:47], v[56:59], v[4:7]
    v_mfma_f32_16x16x32_bf16 v[4:7], v[48:51], v[52:55], v[4:7]
    v_add_u32 v148, 64, v148
    v_add_u32 v149, 64, v149
    s_waitcnt lgkmcnt(0)
    v_mfma_f32_16x16x32_bf16 v[0:3], v[84:87], v[140:143], v[0:3]
    ds_read_b128 v[52:55], v149 offset:3584
    ds_read_b64 v[20:21], v148 offset:0
    ds_read_b64 v[22:23], v148 offset:8
    v_mfma_f32_16x16x32_bf16 v[4:7], v[84:87], v[144:147], v[4:7]
    ds_read_b128 v[56:59], v149 offset:3072
    ds_read_b64 v[24:25], v148 offset:512
    v_mfma_f32_16x16x32_bf16 v[0:3], v[88:91], v[136:139], v[0:3]
    ds_read_b64 v[26:27], v148 offset:520
    ds_read_b128 v[60:63], v149 offset:2560
    v_mfma_f32_16x16x32_bf16 v[4:7], v[88:91], v[140:143], v[4:7]
    ds_read_b64 v[28:29], v148 offset:1024
    ds_read_b64 v[30:31], v148 offset:1032
    v_mfma_f32_16x16x32_bf16 v[0:3], v[92:95], v[132:135], v[0:3]
    ds_read_b128 v[64:67], v149 offset:2048
    ds_read_b64 v[32:33], v148 offset:1536
    v_mfma_f32_16x16x32_bf16 v[4:7], v[92:95], v[136:139], v[4:7]
    ds_read_b64 v[34:35], v148 offset:1544
    ds_read_b128 v[68:71], v149 offset:1536
    v_mfma_f32_16x16x32_bf16 v[0:3], v[96:99], v[128:131], v[0:3]
    ds_read_b64 v[36:37], v148 offset:2048
    ds_read_b64 v[38:39], v148 offset:2056
    v_mfma_f32_16x16x32_bf16 v[4:7], v[96:99], v[132:135], v[4:7]
    ds_read_b128 v[72:75], v149 offset:1024
    ds_read_b64 v[40:41], v148 offset:2560
    ds_read_b64 v[42:43], v148 offset:2568
    v_mfma_f32_16x16x32_bf16 v[0:3], v[100:103], v[124:127], v[0:3]
    ds_read_b128 v[76:79], v149 offset:512
    ds_read_b64 v[44:45], v148 offset:3072
    v_mfma_f32_16x16x32_bf16 v[4:7], v[100:103], v[128:131], v[4:7]
    ds_read_b64 v[46:47], v148 offset:3080
    ds_read_b128 v[80:83], v149 offset:0
    v_mfma_f32_16x16x32_bf16 v[0:3], v[104:107], v[120:123], v[0:3]
    ds_read_b64 v[48:49], v148 offset:3584
    ds_read_b64 v[50:51], v148 offset:3592
    v_mfma_f32_16x16x32_bf16 v[4:7], v[104:107], v[124:127], v[4:7]
    v_mfma_f32_16x16x32_bf16 v[0:3], v[108:111], v[116:119], v[0:3]
    v_mfma_f32_16x16x32_bf16 v[4:7], v[108:111], v[120:123], v[4:7]
    v_mfma_f32_16x16x32_bf16 v[4:7], v[112:115], v[116:119], v[4:7]
    v_add_u32 v148, 64, v148
    v_add_u32 v149, 64, v149
    s_add_u32 s66, s66, 1
    s_cmp_lt_u32 s66, 4
    s_waitcnt lgkmcnt(0)
    s_cbranch_scc1 L_phH2_54
    s_nop 4
    s_lshl_b32 s48, s32, 12
    s_add_u32 s48, s48, 108128
    v_add_u32 v154, s48, v153
    ds_write_b128 v154, v[0:3] offset:0
    ds_write_b128 v154, v[4:7] offset:1024
    s_waitcnt lgkmcnt(0)
    s_mov_b64 exec, 1
    ds_add_u32 v155, v156 offset:20
    s_mov_b64 exec, -1
    s_endpgm
L_k2_expand:
    s_cmp_eq_u32 s32, 0
    s_cbranch_scc0 L_ex_55_1
    v_perm_b32 v10, v40, v40, s96
    v_perm_b32 v11, v41, v40, s98
    v_perm_b32 v12, v41, v41, s96
    v_perm_b32 v13, v44, v41, s98
    v_perm_b32 v14, v44, v44, s96
    v_lshrrev_b32 v15, 16, v44
    v_and_b32 v16, 0xffff, v44
    v_cmp_eq_u32 vcc, 63, v150
    s_nop 1
    v_cndmask_b32 v15, v15, v16, vcc
    s_mov_b32 exec_hi, 0
    v_mov_b32 v10, v40
    v_mov_b32 v11, v41
    v_mov_b32 v12, v42
    v_mov_b32 v13, v43
    v_mov_b32 v14, v44
    v_mov_b32 v15, v45
    v_perm_b32 v16, v44, v44, s96
    v_lshrrev_b32 v17, 16, v44
    v_cmp_eq_u32 vcc, 31, v150
    s_nop 1
    v_cndmask_b32 v14, v14, v16, vcc
    v_cndmask_b32 v15, v15, v17, vcc
    s_mov_b32 exec_hi, -1
    s_branch L_ex_55_d
L_ex_55_1:
    s_cmp_eq_u32 s32, 1
    s_cbranch_scc0 L_ex_55_3
    v_perm_b32 v10, v40, v40, s96
    v_mov_b32 v11, v40
    v_perm_b32 v12, v40, v40, s97
    v_perm_b32 v13, v44, v44, s96
    v_mov_b32 v14, v13
    v_mov_b32 v15, v13
    s_branch L_ex_55_d
L_ex_55_3:
    v_perm_b32 v10, v40, v40, s96
    v_perm_b32 v13, v44, v44, s96
    v_mov_b32 v11, v10
    v_perm_b32 v12, v44, v40, s99
    v_and_b32 v16, 1, v150
    v_cmp_eq_u32 vcc, 1, v16
    v_mov_b32 v14, v13
    v_mov_b32 v15, v13
    v_cndmask_b32 v12, v12, v13, vcc
L_ex_55_d:
    v_alignbit_b32 v20, v11, v10, 16
    v_alignbit_b32 v21, v12, v11, 16
    v_alignbit_b32 v22, v13, v12, 16
    v_alignbit_b32 v23, v14, v13, 16
    v_mov_b32 v24, v11
    v_mov_b32 v25, v12
    v_mov_b32 v26, v13
    v_mov_b32 v27, v14
    v_mov_b32 v28, v21
    v_mov_b32 v29, v22
    v_mov_b32 v30, v23
    v_alignbit_b32 v31, v15, v14, 16
    v_add_u32 v18, s60, v163
    ds_write_b128 v18, v[10:13]
    ds_write_b128 v18, v[20:23] offset:4160
    ds_write_b128 v18, v[24:27] offset:8320
    ds_write_b128 v18, v[28:31] offset:12480
    s_cmp_eq_u32 s32, 0
    s_cbranch_scc0 L_fr_56
    v_readlane_b32 s61, v10, 0
    v_readlane_b32 s62, v11, 0
    v_mov_b32 v16, 0
    s_lshl_b32 s63, s61, 16
    s_lshr_b32 s65, s61, 16
    s_lshl_b32 s62, s62, 16
    s_or_b32 s65, s65, s62
    v_writelane_b32 v16, s63, 15
    v_writelane_b32 v16, s61, 23
    v_writelane_b32 v16, s63, 30
    v_writelane_b32 v16, s65, 31
    v_add_u32 v17, s60, v164
    s_mov_b32 exec_hi, 0
    ds_write_b32 v17, v16
    s_mov_b32 exec_hi, -1
L_fr_56:
    s_setpc_b64 s[58:59]
L_k2_helper:
    s_setprio 3
    s_mul_i32 s64, s32, 21216
    s_waitcnt lgkmcnt(0)
    s_mov_b32 s16, s4
    s_mov_b32 s17, s5
    s_mov_b32 s18, 2621440
    s_mov_b32 s19, 0x00020000
    s_mov_b32 s20, s6
    s_mov_b32 s21, s7
    s_mov_b32 s22, 1280
    s_mov_b32 s23, 0x00020000
    s_mov_b32 s24, s8
    s_mov_b32 s25, s9
    s_mov_b32 s26, 2621440
    s_mov_b32 s27, 0x00020000
    s_mov_b32 s28, s10
    s_mov_b32 s29, s11
    s_mov_b32 s30, 10821632
    s_mov_b32 s31, 0x00020000
    v_and_b32 v2, 15, v150
    v_lshlrev_b32 v2, 1, v2
    s_sub_u32 s44, s32, 16
    v_add_u32 v2, s44, v2
    v_max_i32 v3, 0, v2
    v_lshlrev_b32 v3, 1, v3
    v_add_u32 v4, 1, v2
    v_max_i32 v4, 0, v4
    v_lshlrev_b32 v4, 1, v4
    s_mul_i32 s45, s34, 4224
    s_lshl_b32 s47, s34, 12
    s_lshl_b32 s48, s34, 1
    v_mov_b32 v5, s48
    s_mul_i32 s49, s32, 4160
    s_add_u32 s50, s49, 106112
    s_mov_b32 m0, s50
    s_lshl_b32 s51, s32, 1
    s_add_u32 s51, s51, s47
    buffer_load_dwordx4 v153, s[16:19], s51 offen offset:0  lds
    buffer_load_dwordx4 v153, s[16:19], s51 offen offset:1024  lds
    buffer_load_dwordx4 v153, s[16:19], s51 offen offset:2048  lds
    buffer_load_dwordx4 v153, s[16:19], s51 offen offset:3072  lds
    s_lshl_b32 s48, s32, 10
    s_add_u32 s50, s48, 101504
    s_mov_b32 m0, s50
    s_add_u32 s51, s45, s48
    s_add_u32 s51, s51, 0
    buffer_load_dwordx4 v153, s[28:31], s51 offen  lds
    s_add_u32 s50, s48, 122720
    s_mov_b32 m0, s50
    s_add_u32 s51, s45, s48
    s_add_u32 s51, s51, 2703360
    buffer_load_dwordx4 v153, s[28:31], s51 offen  lds
    buffer_load_ushort v50, v3, s[16:19], s47 offen
    buffer_load_ushort v51, v4, s[16:19], s47 offen
    buffer_load_ushort v52, v5, s[20:23], 0 offen
    s_lshl_b32 s48, s32, 11
    s_add_u32 s50, s48, 127296
    s_mov_b32 m0, s50
    s_add_u32 s51, s48, 10813440
    buffer_load_dwordx4 v153, s[28:31], s51 offen  lds
    buffer_load_dwordx4 v153, s[28:31], s51 offen offset:1024  lds
    s_waitcnt lgkmcnt(0)
    s_barrier
    s_lshl_b32 s54, s33, 12
    s_lshl_b32 s55, s32, 1
    s_add_u32 s54, s54, s55
    s_add_u32 s55, s54, 4096
    s_add_u32 s56, s49, 21248
    s_add_u32 s57, s49, 63680
    s_lshr_b32 s58, s32, 1
    s_add_u32 s58, s58, s33
    s_mul_i32 s58, s58, 4224
    s_and_b32 s59, s32, 1
    s_cmp_eq_u32 s59, 1
    s_cselect_b32 s59, 2703360, 0
    s_add_u32 s58, s58, s59
    s_add_u32 s59, s64, 16640
    s_mov_b32 m0, s56
    s_nop 0
    buffer_load_dwordx4 v153, s[16:19], s54 offen offset:0  lds
    buffer_load_dwordx4 v153, s[16:19], s54 offen offset:1024  lds
    s_mov_b32 m0, s57
    s_nop 0
    buffer_load_dwordx4 v153, s[16:19], s55 offen offset:0  lds
    buffer_load_dwordx4 v153, s[16:19], s55 offen offset:1024  lds
    s_mov_b32 m0, s59
    s_nop 0
    buffer_load_dwordx4 v153, s[28:31], s58 offen offset:2048  lds
    buffer_load_dwordx4 v153, s[28:31], s58 offen offset:3072  lds
    v_and_b32 v2, 15, v150
    v_lshlrev_b32 v2, 1, v2
    v_add_u32 v53, s44, v2
    v_bfe_u32 v6, v150, 4, 1
    v_max_i32 v3, 0, v53
    v_lshlrev_b32 v3, 1, v3
    v_lshl_add_u32 v3, v6, 12, v3
    v_add_u32 v4, 1, v53
    v_max_i32 v4, 0, v4
    v_lshlrev_b32 v4, 1, v4
    v_lshl_add_u32 v4, v6, 12, v4
    s_lshl_b32 s48, s33, 12
    v_add_u32 v5, s33, v6
    v_lshlrev_b32 v5, 1, v5
    buffer_load_ushort v72, v3, s[16:19], s48 offen
    buffer_load_ushort v73, v4, s[16:19], s48 offen
    buffer_load_ushort v74, v5, s[20:23], 0 offen
    v_mul_u32_u24 v75, 42432, v6
    v_mov_b32 v8, 0
    v_mov_b32 v9, 0
    v_mov_b32 v10, 0
    v_mov_b32 v11, 0
    s_add_u32 s41, s64, 20736
    v_add_u32 v6, s41, v153
    v_cmp_gt_u32 vcc, 30, v150
    s_and_saveexec_b64 s[42:43], vcc
    ds_write_b128 v6, v[8:11]
    s_cmp_lt_u32 s32, 2
    s_cbranch_scc0 L_k2_notail2
    v_add_u32 v6, 84864, v6
    ds_write_b128 v6, v[8:11]
L_k2_notail2:
    s_mov_b64 exec, s[42:43]
    s_waitcnt vmcnt(9)
    v_and_b32 v2, 15, v150
    v_lshlrev_b32 v3, 1, v2
    v_add_u32 v3, s44, v3
    s_add_u32 s50, s49, 106080
    v_lshl_add_u32 v4, v2, 2, s50
    v_lshlrev_b32 v50, 16, v50
    v_lshlrev_b32 v51, 16, v51
    v_lshlrev_b32 v52, 16, v52
    v_cmp_le_i32 vcc, 0, v3
    v_mov_b32 v8, 0
    s_nop 0
    v_cndmask_b32 v50, v8, v50, vcc
    v_cmp_le_i32 vcc, -1, v3
    s_nop 1
    v_cndmask_b32 v51, v8, v51, vcc
    v_cmp_eq_u32 vcc, 0, v3
    s_nop 1
    v_cndmask_b32 v9, v8, v52, vcc
    v_add_f32 v50, v50, v9
    v_cmp_eq_u32 vcc, -1, v3
    s_nop 1
    v_cndmask_b32 v9, v8, v52, vcc
    v_add_f32 v51, v51, v9
    v_cvt_pk_bf16_f32 v50, v50, v51
    ds_write_b32 v4, v50
    s_waitcnt lgkmcnt(0)
    s_mov_b64 exec, 1
    ds_add_u32 v155, v156 offset:0
    s_mov_b64 exec, -1
    s_mov_b32 m0, s56
    s_nop 0
    buffer_load_dwordx4 v153, s[16:19], s54 offen offset:2048  lds
    buffer_load_dwordx4 v153, s[16:19], s54 offen offset:3072  lds
    s_mov_b32 m0, s57
    s_nop 0
    buffer_load_dwordx4 v153, s[16:19], s55 offen offset:2048  lds
    buffer_load_dwordx4 v153, s[16:19], s55 offen offset:3072  lds
    s_mov_b32 m0, s59
    s_nop 0
    buffer_load_dwordx4 v153, s[28:31], s58 offen offset:0  lds
    buffer_load_dwordx4 v153, s[28:31], s58 offen offset:1024  lds
    s_waitcnt vmcnt(6)
    v_and_b32 v2, 15, v150
    s_add_u32 s50, s49, 21216
    v_lshl_add_u32 v4, v2, 2, s50
    v_add_u32 v4, v4, v75
    v_lshlrev_b32 v72, 16, v72
    v_lshlrev_b32 v73, 16, v73
    v_lshlrev_b32 v74, 16, v74
    v_cmp_le_i32 vcc, 0, v53
    v_mov_b32 v8, 0
    s_nop 0
    v_cndmask_b32 v72, v8, v72, vcc
    v_cmp_le_i32 vcc, -1, v53
    s_nop 1
    v_cndmask_b32 v73, v8, v73, vcc
    v_cmp_eq_u32 vcc, 0, v53
    s_nop 1
    v_cndmask_b32 v9, v8, v74, vcc
    v_add_f32 v72, v72, v9
    v_cmp_eq_u32 vcc, -1, v53
    s_nop 1
    v_cndmask_b32 v9, v8, v74, vcc
    v_add_f32 v73, v73, v9
    v_cvt_pk_bf16_f32 v72, v72, v73
    ds_write_b32 v4, v72
    s_waitcnt lgkmcnt(0)
    s_mov_b64 exec, 1
    ds_add_u32 v155, v156 offset:24
    s_mov_b64 exec, -1
    s_waitcnt vmcnt(0)
    s_mov_b64 exec, 1
    ds_add_u32 v155, v156 offset:28
    s_mov_b64 exec, -1
    v_and_b32 v40, 15, v150
    v_lshrrev_b32 v41, 4, v150
    v_lshlrev_b32 v40, 4, v40
    v_lshl_add_u32 v40, v41, 2, v40
    v_lshlrev_b32 v41, 2, v40
    v_add_u32 v41, 127296, v41
    v_lshlrev_b32 v42, 1, v40
    v_sub_u32 v42, 20728, v42
    v_mul_u32_u24 v46, 1280, v40
    s_mov_b32 s46, 0xffff0000
    s_mov_b32 s69, 0x40000
L_spin_57:
    ds_read_b32 v158, v155 offset:0
    s_waitcnt lgkmcnt(0)
    v_readfirstlane_b32 s68, v158
    s_sub_u32 s69, s69, 1
    s_cbranch_scc1 L_spin_57_done
    s_cmp_ge_u32 s68, 8
    s_cbranch_scc1 L_spin_57_done
    s_sleep 1
    s_branch L_spin_57
L_spin_57_done:
    s_cmp_eq_u32 s35, 0
    s_cbranch_scc0 L_k2_hO
    s_cmp_lt_u32 s32, 3
    s_cbranch_scc0 L_sepi_58
    s_cmp_lt_u32 s32, 1
    s_cbranch_scc0 L_w1_59
    s_mov_b32 s69, 0x40000
L_spin_60:
    ds_read_b32 v158, v155 offset:4
    s_waitcnt lgkmcnt(0)
    v_readfirstlane_b32 s68, v158
    s_sub_u32 s69, s69, 1
    s_cbranch_scc1 L_spin_60_done
    s_cmp_ge_u32 s68, 4
    s_cbranch_scc1 L_spin_60_done
    s_sleep 1
    s_branch L_spin_60
L_spin_60_done:
    s_branch L_w1_59_d
L_w1_59:
    s_mov_b32 s69, 0x40000
L_spin_61:
    ds_read_b32 v158, v155 offset:8
    s_waitcnt lgkmcnt(0)
    v_readfirstlane_b32 s68, v158
    s_sub_u32 s69, s69, 1
    s_cbranch_scc1 L_spin_61_done
    s_cmp_ge_u32 s68, 4
    s_cbranch_scc1 L_spin_61_done
    s_sleep 1
    s_branch L_spin_61
L_spin_61_done:
L_w1_59_d:
    s_mov_b32 s50, 2
    s_cmp_eq_u32 s32, 1
    s_cselect_b32 s50, 7, s50
    s_cmp_eq_u32 s32, 2
    s_cselect_b32 s50, 6, s50
    s_lshl_b32 s48, s32, 10
    s_add_u32 s48, s48, 135488
    v_add_u32 v43, s48, v153
    ds_read_b128 v[48:51], v43
    ds_read_b128 v[52:55], v43 offset:5120
    ds_read_b128 v[56:59], v43 offset:10240
    ds_read_b128 v[60:63], v43 offset:15360
    s_lshl_b32 s48, s50, 10
    v_add_u32 v44, s48, v41
    ds_read_b128 v[64:67], v44
    s_lshl_b32 s48, s50, 9
    s_sub_u32 s48, 84864, s48
    v_add_u32 v44, s48, v42
    ds_read_b64 v[68:69], v44
    s_mul_i32 s50, s50, 327680
    s_lshl_b32 s48, s34, 1
    v_add_u32 v45, s48, v46
    s_waitcnt lgkmcnt(0)
    v_pk_add_f32 v[48:49], v[48:49], v[56:57]
    v_pk_add_f32 v[50:51], v[50:51], v[58:59]
    v_pk_add_f32 v[52:53], v[52:53], v[60:61]
    v_pk_add_f32 v[54:55], v[54:55], v[62:63]
    v_and_b32 v104, s46, v69
    v_lshlrev_b32 v105, 16, v69
    v_and_b32 v106, s46, v68
    v_lshlrev_b32 v107, 16, v68
    v_pk_fma_f32 v[104:105], v[104:105], v[52:53], v[48:49] neg_lo:[0,0,1] neg_hi:[0,0,1]
    v_pk_fma_f32 v[106:107], v[106:107], v[54:55], v[50:51] neg_lo:[0,0,1] neg_hi:[0,0,1]
    v_pk_fma_f32 v[72:73], v[64:65], v[104:105], v[48:49]
    v_pk_fma_f32 v[74:75], v[66:67], v[106:107], v[50:51]
    v_cvt_pk_bf16_f32 v72, v72, v73
    v_cvt_pk_bf16_f32 v74, v74, v75
    buffer_store_short v72, v45, s[24:27], s50 offen
    buffer_store_short_d16_hi v72, v45, s[24:27], s50 offen offset:1280
    buffer_store_short v74, v45, s[24:27], s50 offen offset:2560
    buffer_store_short_d16_hi v74, v45, s[24:27], s50 offen offset:3840
L_sepi_58:
    s_branch L_k2_hSdone
L_k2_hO:
    s_cmp_lt_u32 s32, 4
    s_cbranch_scc0 L_sepi_62
    s_cmp_lt_u32 s32, 2
    s_cbranch_scc0 L_w1_63
    s_mov_b32 s69, 0x40000
L_spin_64:
    ds_read_b32 v158, v155 offset:4
    s_waitcnt lgkmcnt(0)
    v_readfirstlane_b32 s68, v158
    s_sub_u32 s69, s69, 1
    s_cbranch_scc1 L_spin_64_done
    s_cmp_ge_u32 s68, 4
    s_cbranch_scc1 L_spin_64_done
    s_sleep 1
    s_branch L_spin_64
L_spin_64_done:
    s_branch L_w1_63_d
L_w1_63:
    s_mov_b32 s69, 0x40000
L_spin_65:
    ds_read_b32 v158, v155 offset:8
    s_waitcnt lgkmcnt(0)
    v_readfirstlane_b32 s68, v158
    s_sub_u32 s69, s69, 1
    s_cbranch_scc1 L_spin_65_done
    s_cmp_ge_u32 s68, 4
    s_cbranch_scc1 L_spin_65_done
    s_sleep 1
    s_branch L_spin_65
L_spin_65_done:
L_w1_63_d:
    s_mov_b32 s50, 1
    s_cmp_eq_u32 s32, 1
    s_cselect_b32 s50, 0, s50
    s_cmp_eq_u32 s32, 2
    s_cselect_b32 s50, 5, s50
    s_cmp_eq_u32 s32, 3
    s_cselect_b32 s50, 4, s50
    s_lshl_b32 s48, s32, 10
    s_add_u32 s48, s48, 135488
    v_add_u32 v43, s48, v153
    ds_read_b128 v[48:51], v43
    ds_read_b128 v[52:55], v43 offset:5120
    ds_read_b128 v[56:59], v43 offset:10240
    ds_read_b128 v[60:63], v43 offset:15360
    s_lshl_b32 s48, s50, 10
    v_add_u32 v44, s48, v41
    ds_read_b128 v[64:67], v44
    s_lshl_b32 s48, s50, 9
    s_sub_u32 s48, 84864, s48
    v_add_u32 v44, s48, v42
    ds_read_b64 v[68:69], v44
    s_mul_i32 s50, s50, 327680
    s_lshl_b32 s48, s34, 1
    v_add_u32 v45, s48, v46
    s_waitcnt lgkmcnt(0)
    v_pk_add_f32 v[48:49], v[48:49], v[56:57]
    v_pk_add_f32 v[50:51], v[50:51], v[58:59]
    v_pk_add_f32 v[52:53], v[52:53], v[60:61]
    v_pk_add_f32 v[54:55], v[54:55], v[62:63]
    v_and_b32 v104, s46, v69
    v_lshlrev_b32 v105, 16, v69
    v_and_b32 v106, s46, v68
    v_lshlrev_b32 v107, 16, v68
    v_pk_fma_f32 v[104:105], v[104:105], v[52:53], v[48:49] neg_lo:[0,0,1] neg_hi:[0,0,1]
    v_pk_fma_f32 v[106:107], v[106:107], v[54:55], v[50:51] neg_lo:[0,0,1] neg_hi:[0,0,1]
    v_pk_fma_f32 v[72:73], v[64:65], v[104:105], v[48:49]
    v_pk_fma_f32 v[74:75], v[66:67], v[106:107], v[50:51]
    v_cvt_pk_bf16_f32 v72, v72, v73
    v_cvt_pk_bf16_f32 v74, v74, v75
    buffer_store_short v72, v45, s[24:27], s50 offen
    buffer_store_short_d16_hi v72, v45, s[24:27], s50 offen offset:1280
    buffer_store_short v74, v45, s[24:27], s50 offen offset:2560
    buffer_store_short_d16_hi v74, v45, s[24:27], s50 offen offset:3840
L_sepi_62:
    s_cmp_lt_u32 s32, 1
    s_cbranch_scc0 L_sepi_66
    s_mov_b32 s69, 0x40000
L_spin_67:
    ds_read_b32 v158, v155 offset:8
    s_waitcnt lgkmcnt(0)
    v_readfirstlane_b32 s68, v158
    s_sub_u32 s69, s69, 1
    s_cbranch_scc1 L_spin_67_done
    s_cmp_ge_u32 s68, 4
    s_cbranch_scc1 L_spin_67_done
    s_sleep 1
    s_branch L_spin_67
L_spin_67_done:
    s_mov_b32 s50, 3
    s_lshl_b32 s48, s32, 10
    s_add_u32 s48, s48, 139584
    v_add_u32 v43, s48, v153
    ds_read_b128 v[48:51], v43
    ds_read_b128 v[52:55], v43 offset:5120
    ds_read_b128 v[56:59], v43 offset:10240
    ds_read_b128 v[60:63], v43 offset:15360
    s_lshl_b32 s48, s50, 10
    v_add_u32 v44, s48, v41
    ds_read_b128 v[64:67], v44
    s_lshl_b32 s48, s50, 9
    s_sub_u32 s48, 84864, s48
    v_add_u32 v44, s48, v42
    ds_read_b64 v[68:69], v44
    s_mul_i32 s50, s50, 327680
    s_lshl_b32 s48, s34, 1
    v_add_u32 v45, s48, v46
    s_waitcnt lgkmcnt(0)
    v_pk_add_f32 v[48:49], v[48:49], v[56:57]
    v_pk_add_f32 v[50:51], v[50:51], v[58:59]
    v_pk_add_f32 v[52:53], v[52:53], v[60:61]
    v_pk_add_f32 v[54:55], v[54:55], v[62:63]
    v_and_b32 v104, s46, v69
    v_lshlrev_b32 v105, 16, v69
    v_and_b32 v106, s46, v68
    v_lshlrev_b32 v107, 16, v68
    v_pk_fma_f32 v[104:105], v[104:105], v[52:53], v[48:49] neg_lo:[0,0,1] neg_hi:[0,0,1]
    v_pk_fma_f32 v[106:107], v[106:107], v[54:55], v[50:51] neg_lo:[0,0,1] neg_hi:[0,0,1]
    v_pk_fma_f32 v[72:73], v[64:65], v[104:105], v[48:49]
    v_pk_fma_f32 v[74:75], v[66:67], v[106:107], v[50:51]
    v_cvt_pk_bf16_f32 v72, v72, v73
    v_cvt_pk_bf16_f32 v74, v74, v75
    buffer_store_short v72, v45, s[24:27], s50 offen
    buffer_store_short_d16_hi v72, v45, s[24:27], s50 offen offset:1280
    buffer_store_short v74, v45, s[24:27], s50 offen offset:2560
    buffer_store_short_d16_hi v74, v45, s[24:27], s50 offen offset:3840
L_sepi_66:
L_k2_hSdone:
    s_mov_b32 s69, 0x40000
L_spin_68:
    ds_read_b32 v158, v155 offset:12
    s_waitcnt lgkmcnt(0)
    v_readfirstlane_b32 s68, v158
    s_sub_u32 s69, s69, 1
    s_cbranch_scc1 L_spin_68_done
    s_cmp_ge_u32 s68, 4
    s_cbranch_scc1 L_spin_68_done
    s_sleep 1
    s_branch L_spin_68
L_spin_68_done:
    s_lshl_b32 s48, s32, 10
    s_add_u32 s48, s48, 84864
    v_add_u32 v43, s48, v153
    ds_read_b128 v[48:51], v43
    ds_read_b128 v[52:55], v43 offset:4096
    ds_read_b128 v[56:59], v43 offset:8192
    ds_read_b128 v[60:63], v43 offset:12288
    s_add_u32 s50, s32, 0
    s_lshl_b32 s48, s50, 10
    v_add_u32 v44, s48, v41
    ds_read_b128 v[64:67], v44
    s_lshl_b32 s48, s50, 9
    v_subrev_u32 v44, s48, v42
    ds_read_b64 v[68:69], v44
    ds_read_b64 v[70:71], v44 offset:42432
    s_mul_i32 s50, s50, 327680
    s_lshl_b32 s48, s33, 1
    v_add_u32 v45, s48, v46
    s_waitcnt lgkmcnt(0)
    v_and_b32 v104, s46, v69
    v_lshlrev_b32 v105, 16, v69
    v_and_b32 v106, s46, v68
    v_lshlrev_b32 v107, 16, v68
    v_pk_fma_f32 v[104:105], v[104:105], v[52:53], v[48:49] neg_lo:[0,0,1] neg_hi:[0,0,1]
    v_pk_fma_f32 v[106:107], v[106:107], v[54:55], v[50:51] neg_lo:[0,0,1] neg_hi:[0,0,1]
    v_pk_fma_f32 v[72:73], v[64:65], v[104:105], v[48:49]
    v_pk_fma_f32 v[74:75], v[66:67], v[106:107], v[50:51]
    v_and_b32 v104, s46, v71
    v_lshlrev_b32 v105, 16, v71
    v_and_b32 v106, s46, v70
    v_lshlrev_b32 v107, 16, v70
    v_pk_fma_f32 v[104:105], v[104:105], v[60:61], v[56:57] neg_lo:[0,0,1] neg_hi:[0,0,1]
    v_pk_fma_f32 v[106:107], v[106:107], v[62:63], v[58:59] neg_lo:[0,0,1] neg_hi:[0,0,1]
    v_pk_fma_f32 v[76:77], v[64:65], v[104:105], v[56:57]
    v_pk_fma_f32 v[78:79], v[66:67], v[106:107], v[58:59]
    v_cvt_pk_bf16_f32 v80, v72, v76
    v_cvt_pk_bf16_f32 v81, v73, v77
    v_cvt_pk_bf16_f32 v82, v74, v78
    v_cvt_pk_bf16_f32 v83, v75, v79
    buffer_store_dword v80, v45, s[24:27], s50 offen offset:0
    buffer_store_dword v81, v45, s[24:27], s50 offen offset:1280
    buffer_store_dword v82, v45, s[24:27], s50 offen offset:2560
    buffer_store_dword v83, v45, s[24:27], s50 offen offset:3840
    s_cmp_lt_u32 s32, 2
    s_cbranch_scc0 L_k2_wh2
    s_mov_b32 s69, 0x40000
L_spin_69:
    ds_read_b32 v158, v155 offset:16
    s_waitcnt lgkmcnt(0)
    v_readfirstlane_b32 s68, v158
    s_sub_u32 s69, s69, 1
    s_cbranch_scc1 L_spin_69_done
    s_cmp_ge_u32 s68, 4
    s_cbranch_scc1 L_spin_69_done
    s_sleep 1
    s_branch L_spin_69
L_spin_69_done:
    s_branch L_k2_wh2_d
L_k2_wh2:
    s_mov_b32 s69, 0x40000
L_spin_70:
    ds_read_b32 v158, v155 offset:20
    s_waitcnt lgkmcnt(0)
    v_readfirstlane_b32 s68, v158
    s_sub_u32 s69, s69, 1
    s_cbranch_scc1 L_spin_70_done
    s_cmp_ge_u32 s68, 4
    s_cbranch_scc1 L_spin_70_done
    s_sleep 1
    s_branch L_spin_70
L_spin_70_done:
L_k2_wh2_d:
    s_lshl_b32 s48, s32, 10
    s_add_u32 s48, s48, 106080
    v_add_u32 v43, s48, v153
    ds_read_b128 v[48:51], v43
    ds_read_b128 v[52:55], v43 offset:4096
    ds_read_b128 v[56:59], v43 offset:8192
    ds_read_b128 v[60:63], v43 offset:12288
    s_add_u32 s50, s32, 4
    s_lshl_b32 s48, s50, 10
    v_add_u32 v44, s48, v41
    ds_read_b128 v[64:67], v44
    s_lshl_b32 s48, s50, 9
    v_subrev_u32 v44, s48, v42
    ds_read_b64 v[68:69], v44
    ds_read_b64 v[70:71], v44 offset:42432
    s_mul_i32 s50, s50, 327680
    s_lshl_b32 s48, s33, 1
    v_add_u32 v45, s48, v46
    s_waitcnt lgkmcnt(0)
    v_and_b32 v104, s46, v69
    v_lshlrev_b32 v105, 16, v69
    v_and_b32 v106, s46, v68
    v_lshlrev_b32 v107, 16, v68
    v_pk_fma_f32 v[104:105], v[104:105], v[52:53], v[48:49] neg_lo:[0,0,1] neg_hi:[0,0,1]
    v_pk_fma_f32 v[106:107], v[106:107], v[54:55], v[50:51] neg_lo:[0,0,1] neg_hi:[0,0,1]
    v_pk_fma_f32 v[72:73], v[64:65], v[104:105], v[48:49]
    v_pk_fma_f32 v[74:75], v[66:67], v[106:107], v[50:51]
    v_and_b32 v104, s46, v71
    v_lshlrev_b32 v105, 16, v71
    v_and_b32 v106, s46, v70
    v_lshlrev_b32 v107, 16, v70
    v_pk_fma_f32 v[104:105], v[104:105], v[60:61], v[56:57] neg_lo:[0,0,1] neg_hi:[0,0,1]
    v_pk_fma_f32 v[106:107], v[106:107], v[62:63], v[58:59] neg_lo:[0,0,1] neg_hi:[0,0,1]
    v_pk_fma_f32 v[76:77], v[64:65], v[104:105], v[56:57]
    v_pk_fma_f32 v[78:79], v[66:67], v[106:107], v[58:59]
    v_cvt_pk_bf16_f32 v80, v72, v76
    v_cvt_pk_bf16_f32 v81, v73, v77
    v_cvt_pk_bf16_f32 v82, v74, v78
    v_cvt_pk_bf16_f32 v83, v75, v79
    buffer_store_dword v80, v45, s[24:27], s50 offen offset:0
    buffer_store_dword v81, v45, s[24:27], s50 offen offset:1280
    buffer_store_dword v82, v45, s[24:27], s50 offen offset:2560
    buffer_store_dword v83, v45, s[24:27], s50 offen offset:3840
L_k2_end:
    s_endpgm
.section .rodata,"a"
.p2align 6
.amdhsa_kernel k1_kernel
  .amdhsa_next_free_vgpr 104
  .amdhsa_next_free_sgpr 100
  .amdhsa_accum_offset 104
  .amdhsa_group_segment_fixed_size 0
  .amdhsa_kernarg_size 136
  .amdhsa_user_sgpr_count 2
  .amdhsa_user_sgpr_kernarg_segment_ptr 1
  .amdhsa_system_sgpr_workgroup_id_x 1
  .amdhsa_float_denorm_mode_32 3
.end_amdhsa_kernel
.p2align 6
L_kd2:
.amdhsa_kernel k2_kernel
  .amdhsa_next_free_vgpr 168
  .amdhsa_next_free_sgpr 100
  .amdhsa_accum_offset 168
  .amdhsa_group_segment_fixed_size 0
  .amdhsa_kernarg_size 136
  .amdhsa_user_sgpr_count 2
  .amdhsa_user_sgpr_kernarg_segment_ptr 1
  .amdhsa_system_sgpr_workgroup_id_x 1
  .amdhsa_float_denorm_mode_32 3
.end_amdhsa_kernel
```
